```python
import torch

def _softmax(x, axis=-1):
    return torch.softmax(x, dim=axis)
def _gelu(x):
    return torch.nn.functional.gelu(x, approximate="tanh")
def _silu(x):
    return torch.nn.functional.silu(x)
def _sigmoid(x):
    return torch.sigmoid(x)
def _layernorm(x, axis=-1, eps=1e-5):
    m = x.mean(dim=axis, keepdim=True)
    v = x.var(dim=axis, keepdim=True, unbiased=False)
    return (x - m) / torch.sqrt(v + eps)
def _scatter_add(tgt, idx, src, axis=0):
    return tgt.clone().index_add_(axis, idx, src)
def _segment_sum(src, seg, n):
    out = torch.zeros((n,) + src.shape[1:], dtype=src.dtype)
    return out.index_add_(0, seg, src)
def _pad(x, pw):
    flat = tuple(v for pair in reversed(pw) for v in pair)
    return torch.nn.functional.pad(x, flat)

kernel_name = 'parallel_sum__linear_kernel_hedgehog__glu_gated_glu__prompt'

def setup_inputs():

    _w = (lambda a: (lambda t: t.to(torch.bfloat16) if t.is_floating_point() else t)(torch.as_tensor(a)))
    def _A_setup():
        B, S, D, H = 1, 2048, 1024, 32
        Dh = D // H
        return {
            "x": _w((lambda *s: torch.randn(*s, dtype=torch.bfloat16) * 0.05)(B, S, D)),
            "wqkv": _w((lambda *s: torch.randn(*s, dtype=torch.bfloat16) * 0.4)(D, 3 * D)),
            "w_phi": _w((lambda *s: torch.randn(*s, dtype=torch.bfloat16) * 0.4)(H, Dh, Dh) * (Dh ** -0.5)),
            "wo": _w((lambda *s: torch.randn(*s, dtype=torch.bfloat16) * 0.1)(D, D)),
        }
    _A_in = _A_setup()

    def _B_setup():
        B, S, D, F = 1, 2048, 1024, 3584
        return {
            "x": _w((lambda *s: torch.randn(*s, dtype=torch.bfloat16) * 0.05)(B, S, D)),
            "w_gate": _w((lambda *s: torch.randn(*s, dtype=torch.bfloat16) * 0.05)(D, F)),
            "w_up": _w((lambda *s: torch.randn(*s, dtype=torch.bfloat16) * 0.05)(D, F)),
            "w_down": _w((lambda *s: torch.randn(*s, dtype=torch.bfloat16) * 0.05)(F, D)),
        }
    _B_in = _B_setup()

    return {
        "A_x": _A_in["x"],
        "A_wqkv": _A_in["wqkv"],
        "A_w_phi": _A_in["w_phi"],
        "A_wo": _A_in["wo"],
        "B_x": _B_in["x"],
        "B_w_gate": _B_in["w_gate"],
        "B_w_up": _B_in["w_up"],
        "B_w_down": _B_in["w_down"],
    }

def reference(A_x, A_wqkv, A_w_phi, A_wo, B_x, B_w_gate, B_w_up, B_w_down):
    def _A_ref(x, wqkv, w_phi, wo):
        B, S, D = x.shape
        H = 32; Dh = D // H
        qkv = (lambda x, *d: x.permute(*d))((x @ wqkv).reshape(B, S, 3, H, Dh), 2, 0, 3, 1, 4)
        q, k, v = qkv[0], qkv[1], qkv[2]
        pq = torch.einsum("bhsd,hdf->bhsf", q, w_phi)
        pk = torch.einsum("bhsd,hdf->bhsf", k, w_phi)
        phi_q = torch.concatenate([_softmax(pq, axis=-1), _softmax(-pq, axis=-1)], axis=-1)
        phi_k = torch.concatenate([_softmax(pk, axis=-1), _softmax(-pk, axis=-1)], axis=-1)
        kv = torch.einsum("bhsf,bhsd->bhfd", phi_k, v)
        z  = torch.einsum("bhsf->bhf", phi_k)
        num = torch.einsum("bhqf,bhfd->bhqd", phi_q, kv)
        den = torch.einsum("bhqf,bhf->bhq", phi_q, z)[..., None] + 1e-6
        o = num / den
        return (lambda x, *d: x.permute(*d))(o, 0, 2, 1, 3).reshape(B, S, D) @ wo

    def _B_ref(x, w_gate, w_up, w_down):
        g = torch.einsum("bsd,df->bsf", x, w_gate)
        u = torch.einsum("bsd,df->bsf", x, w_up)
        h = _sigmoid(g) * u
        return torch.einsum("bsf,fd->bsd", h, w_down)

    x = A_x
    xn = _layernorm(x, axis=-1)
    return x + _A_ref(xn, A_wqkv, A_w_phi, A_wo) + _B_ref(xn, B_w_gate, B_w_up, B_w_down)
```

```asm
; @launch grid=(256,1,1) block=(512,1,1) lds=147520
.amdgcn_target "amdgcn-amd-amdhsa--gfx950"
.text
.globl parallel_sum__linear_kernel_hedgehog__glu_gated_glu__prompt_kernel
.p2align 8
.type parallel_sum__linear_kernel_hedgehog__glu_gated_glu__prompt_kernel,@function
parallel_sum__linear_kernel_hedgehog__glu_gated_glu__prompt_kernel:
    s_cmp_ge_u32 s2, 256
    s_cbranch_scc1 G1_done
    s_cmp_ge_u32 s2, 8
    s_cbranch_scc1 G1_nc0
    s_getpc_b64 s[56:57]
    v_lshlrev_b32 v18, 6, v0
    v_mov_b32 v19, s57
    v_add_co_u32 v18, vcc, s56, v18
    s_nop 1
    v_addc_co_u32 v19, vcc, 0, v19, vcc
    global_load_dword v73, v[18:19], off
G1_nc0:
    s_load_dwordx2 s[62:63], s[0:1], 0
    s_load_dwordx4 s[68:71], s[0:1], 8
    s_load_dwordx4 s[72:75], s[0:1], 40
    s_load_dwordx2 s[76:77], s[0:1], 80
    s_load_dwordx2 s[4:5], s[0:1], 24
    s_load_dwordx2 s[6:7], s[0:1], 56
    v_lshrrev_b32 v16, 6, v0
    v_and_b32 v17, 63, v0
    v_readfirstlane_b32 s3, v16
    s_mov_b32 s79, 0
    v_and_b32 v48, 7, v17
    v_lshrrev_b32 v49, 3, v17
    v_lshlrev_b32 v50, 11, v48
    v_lshl_add_u32 v50, v16, 9, v50
    v_lshl_add_u32 v50, v49, 4, v50
    s_lshl_b32 s61, s2, 14
    s_and_b32 s45, s2, 7
    s_lshr_b32 s46, s2, 3
    s_and_b32 s47, s46, 7
    s_lshr_b32 s48, s46, 3
    s_lshl_b32 s49, s45, 2
    s_add_u32 s49, s49, s48
    s_and_b32 s50, s49, 1
    s_lshr_b32 s51, s49, 1
    s_and_b32 s52, s3, 3
    s_lshr_b32 s53, s3, 2
    s_waitcnt lgkmcnt(0)
    s_mov_b32 s88, s62
    s_and_b32 s89, s63, 0xffff
    s_mov_b32 s90, 4194304
    s_mov_b32 s91, 0x20000
    s_cmp_ge_u32 s3, 4
    s_cbranch_scc1 G1_nx
    buffer_load_dwordx4 v[96:99], v50, s[88:91], s61 offen offset:0
    buffer_load_dwordx4 v[100:103], v50, s[88:91], s61 offen offset:128
    buffer_load_dwordx4 v[104:107], v50, s[88:91], s61 offen offset:256
    buffer_load_dwordx4 v[108:111], v50, s[88:91], s61 offen offset:384
    v_lshlrev_b32 v47, 11, v48
    buffer_load_ushort v47, v47, s[88:91], s61 offen
G1_nx:
    s_mov_b32 s64, s76
    s_and_b32 s65, s77, 0xffff
    s_mov_b32 s66, 268435456
    s_mov_b32 s67, 0x20000
    s_mov_b32 s92, s70
    s_and_b32 s93, s71, 0xffff
    s_mov_b32 s94, 65536
    s_mov_b32 s95, 0x20000
    v_mov_b32 v56, 0
    v_mov_b32 v55, 0
    v_mov_b32 v75, 0
    s_mov_b32 s55, 58802176
    s_cmp_lg_u32 s3, 0
    s_cbranch_scc1 G1_ne0
    buffer_load_dword v55, v56, s[64:67], s55 offen sc1
G1_ne0:
    s_lshl_b32 s54, s47, 19
    s_add_u32 s8, s76, s54
    s_addc_u32 s9, s77, 0
    s_and_b32 s9, s9, 0xffff
    s_mov_b32 s10, 0x80000
    s_mov_b32 s11, 0x20000
    s_lshl_b32 s43, s3, 10
    s_add_u32 s44, s43, 65536
    v_lshlrev_b32 v10, 4, v17
    v_add_u32 v10, s43, v10
    s_mov_b32 s42, 4294959104
    v_lshrrev_b32 v18, 3, v17
    v_and_b32 v19, 7, v17
    v_lshrrev_b32 v20, 3, v17
    v_and_b32 v20, 2, v20
    v_xor_b32 v19, v19, v20
    v_lshrrev_b32 v21, 5, v17
    v_lshlrev_b32 v21, 2, v21
    v_lshrrev_b32 v22, 1, v17
    v_and_b32 v22, 8, v22
    v_add_u32 v21, v21, v22
    v_lshrrev_b32 v22, 2, v17
    v_and_b32 v22, 3, v22
    v_add_u32 v21, v21, v22
    v_and_b32 v22, 3, v17
    v_xor_b32 v22, v22, v20
    s_mov_b32 s55, 7168
    v_mul_lo_u32 v21, v21, s55
    v_lshl_add_u32 v21, v22, 4, v21
    s_add_u32 s55, s3, 0
    s_cmp_ge_u32 s55, 20
    s_cselect_b32 s56, 1, 0
    s_mul_i32 s57, s56, 20
    s_sub_u32 s55, s55, s57
    s_lshr_b32 s57, s55, 2
    s_and_b32 s58, s55, 3
    s_lshl_b32 s59, s51, 1
    s_lshr_b32 s61, s57, 1
    s_add_u32 s59, s59, s61
    s_add_u32 s61, s51, 32
    s_cmp_eq_u32 s50, 0
    s_cselect_b32 s59, s59, s61
    s_lshl_b32 s59, s59, 7
    s_and_b32 s61, s57, 1
    s_mov_b32 s62, 7168
    s_lshl_b32 s63, s58, 3
    s_mov_b32 s78, 0
    s_cmp_eq_u32 s57, 4
    s_cbranch_scc0 G1R0_n4
    s_cmp_eq_u32 s50, 0
    s_cbranch_scc0 G1R0_gu
    s_lshl_b32 s59, s51, 7
    s_mov_b32 s61, 2
    s_mov_b32 s62, 6144
    s_branch G1R0_done
G1R0_gu:
    s_lshl_b32 s59, s51, 6
    s_add_u32 s59, s59, 6144
    s_lshr_b32 s61, s58, 1
    s_and_b32 s63, s58, 1
    s_lshl_b32 s63, s63, 4
    s_mov_b32 s78, 1
    s_branch G1R0_done
G1R0_n4:
    s_cmp_ge_u32 s57, 2
    s_cbranch_scc0 G1R0_done
    s_cmp_eq_u32 s50, 1
    s_cbranch_scc0 G1R0_done
    s_sub_u32 s59, s57, 1
    s_lshl_b32 s59, s59, 11
    s_lshl_b32 s61, s51, 7
    s_add_u32 s59, s59, s61
    s_mov_b32 s61, 2
    s_mov_b32 s62, 6144
G1R0_done:
    s_cmp_eq_u32 s61, 0
    s_cselect_b32 s12, s72, s74
    s_cselect_b32 s13, s73, s75
    s_cmp_eq_u32 s61, 2
    s_cselect_b32 s12, s68, s12
    s_cselect_b32 s13, s69, s13
    s_and_b32 s13, s13, 0xffff
    s_lshl_b32 s14, s62, 10
    s_mov_b32 s15, 0x20000
    s_lshl_b32 s56, s56, 5
    s_add_u32 s56, s56, s63
    s_mul_i32 s56, s56, s62
    s_add_u32 s32, s56, s59
    s_lshl_b32 s37, s62, 6
    s_sub_u32 s32, s32, s37
    v_mul_lo_u32 v22, v18, s62
    s_and_b32 s56, s58, 1
    s_lshl_b32 s56, s56, 2
    v_xor_b32 v23, s56, v19
    v_lshl_add_u32 v22, v23, 4, v22
    s_cmp_eq_u32 s78, 1
    s_cselect_b64 vcc, -1, 0
    v_cndmask_b32 v11, v22, v21, vcc
    s_add_u32 s55, s3, 8
    s_cmp_ge_u32 s55, 20
    s_cselect_b32 s56, 1, 0
    s_mul_i32 s57, s56, 20
    s_sub_u32 s55, s55, s57
    s_lshr_b32 s57, s55, 2
    s_and_b32 s58, s55, 3
    s_lshl_b32 s59, s51, 1
    s_lshr_b32 s61, s57, 1
    s_add_u32 s59, s59, s61
    s_add_u32 s61, s51, 32
    s_cmp_eq_u32 s50, 0
    s_cselect_b32 s59, s59, s61
    s_lshl_b32 s59, s59, 7
    s_and_b32 s61, s57, 1
    s_mov_b32 s62, 7168
    s_lshl_b32 s63, s58, 3
    s_mov_b32 s78, 0
    s_cmp_eq_u32 s57, 4
    s_cbranch_scc0 G1R1_n4
    s_cmp_eq_u32 s50, 0
    s_cbranch_scc0 G1R1_gu
    s_lshl_b32 s59, s51, 7
    s_mov_b32 s61, 2
    s_mov_b32 s62, 6144
    s_branch G1R1_done
G1R1_gu:
    s_lshl_b32 s59, s51, 6
    s_add_u32 s59, s59, 6144
    s_lshr_b32 s61, s58, 1
    s_and_b32 s63, s58, 1
    s_lshl_b32 s63, s63, 4
    s_mov_b32 s78, 1
    s_branch G1R1_done
G1R1_n4:
    s_cmp_ge_u32 s57, 2
    s_cbranch_scc0 G1R1_done
    s_cmp_eq_u32 s50, 1
    s_cbranch_scc0 G1R1_done
    s_sub_u32 s59, s57, 1
    s_lshl_b32 s59, s59, 11
    s_lshl_b32 s61, s51, 7
    s_add_u32 s59, s59, s61
    s_mov_b32 s61, 2
    s_mov_b32 s62, 6144
G1R1_done:
    s_cmp_eq_u32 s61, 0
    s_cselect_b32 s16, s72, s74
    s_cselect_b32 s17, s73, s75
    s_cmp_eq_u32 s61, 2
    s_cselect_b32 s16, s68, s16
    s_cselect_b32 s17, s69, s17
    s_and_b32 s17, s17, 0xffff
    s_lshl_b32 s18, s62, 10
    s_mov_b32 s19, 0x20000
    s_lshl_b32 s56, s56, 5
    s_add_u32 s56, s56, s63
    s_mul_i32 s56, s56, s62
    s_add_u32 s33, s56, s59
    s_lshl_b32 s38, s62, 6
    s_sub_u32 s33, s33, s38
    v_mul_lo_u32 v22, v18, s62
    s_and_b32 s56, s58, 1
    s_lshl_b32 s56, s56, 2
    v_xor_b32 v23, s56, v19
    v_lshl_add_u32 v22, v23, 4, v22
    s_cmp_eq_u32 s78, 1
    s_cselect_b64 vcc, -1, 0
    v_cndmask_b32 v12, v22, v21, vcc
    s_add_u32 s55, s3, 16
    s_cmp_ge_u32 s55, 20
    s_cselect_b32 s56, 1, 0
    s_mul_i32 s57, s56, 20
    s_sub_u32 s55, s55, s57
    s_lshr_b32 s57, s55, 2
    s_and_b32 s58, s55, 3
    s_lshl_b32 s59, s51, 1
    s_lshr_b32 s61, s57, 1
    s_add_u32 s59, s59, s61
    s_add_u32 s61, s51, 32
    s_cmp_eq_u32 s50, 0
    s_cselect_b32 s59, s59, s61
    s_lshl_b32 s59, s59, 7
    s_and_b32 s61, s57, 1
    s_mov_b32 s62, 7168
    s_lshl_b32 s63, s58, 3
    s_mov_b32 s78, 0
    s_cmp_eq_u32 s57, 4
    s_cbranch_scc0 G1R2_n4
    s_cmp_eq_u32 s50, 0
    s_cbranch_scc0 G1R2_gu
    s_lshl_b32 s59, s51, 7
    s_mov_b32 s61, 2
    s_mov_b32 s62, 6144
    s_branch G1R2_done
G1R2_gu:
    s_lshl_b32 s59, s51, 6
    s_add_u32 s59, s59, 6144
    s_lshr_b32 s61, s58, 1
    s_and_b32 s63, s58, 1
    s_lshl_b32 s63, s63, 4
    s_mov_b32 s78, 1
    s_branch G1R2_done
G1R2_n4:
    s_cmp_ge_u32 s57, 2
    s_cbranch_scc0 G1R2_done
    s_cmp_eq_u32 s50, 1
    s_cbranch_scc0 G1R2_done
    s_sub_u32 s59, s57, 1
    s_lshl_b32 s59, s59, 11
    s_lshl_b32 s61, s51, 7
    s_add_u32 s59, s59, s61
    s_mov_b32 s61, 2
    s_mov_b32 s62, 6144
G1R2_done:
    s_cmp_eq_u32 s61, 0
    s_cselect_b32 s20, s72, s74
    s_cselect_b32 s21, s73, s75
    s_cmp_eq_u32 s61, 2
    s_cselect_b32 s20, s68, s20
    s_cselect_b32 s21, s69, s21
    s_and_b32 s21, s21, 0xffff
    s_lshl_b32 s22, s62, 10
    s_mov_b32 s23, 0x20000
    s_lshl_b32 s56, s56, 5
    s_add_u32 s56, s56, s63
    s_mul_i32 s56, s56, s62
    s_add_u32 s34, s56, s59
    s_lshl_b32 s39, s62, 6
    s_sub_u32 s34, s34, s39
    v_mul_lo_u32 v22, v18, s62
    s_and_b32 s56, s58, 1
    s_lshl_b32 s56, s56, 2
    v_xor_b32 v23, s56, v19
    v_lshl_add_u32 v22, v23, 4, v22
    s_cmp_eq_u32 s78, 1
    s_cselect_b64 vcc, -1, 0
    v_cndmask_b32 v13, v22, v21, vcc
    s_add_u32 s55, s3, 24
    s_cmp_ge_u32 s55, 20
    s_cselect_b32 s56, 1, 0
    s_mul_i32 s57, s56, 20
    s_sub_u32 s55, s55, s57
    s_lshr_b32 s57, s55, 2
    s_and_b32 s58, s55, 3
    s_lshl_b32 s59, s51, 1
    s_lshr_b32 s61, s57, 1
    s_add_u32 s59, s59, s61
    s_add_u32 s61, s51, 32
    s_cmp_eq_u32 s50, 0
    s_cselect_b32 s59, s59, s61
    s_lshl_b32 s59, s59, 7
    s_and_b32 s61, s57, 1
    s_mov_b32 s62, 7168
    s_lshl_b32 s63, s58, 3
    s_mov_b32 s78, 0
    s_cmp_eq_u32 s57, 4
    s_cbranch_scc0 G1R3_n4
    s_cmp_eq_u32 s50, 0
    s_cbranch_scc0 G1R3_gu
    s_lshl_b32 s59, s51, 7
    s_mov_b32 s61, 2
    s_mov_b32 s62, 6144
    s_branch G1R3_done
G1R3_gu:
    s_lshl_b32 s59, s51, 6
    s_add_u32 s59, s59, 6144
    s_lshr_b32 s61, s58, 1
    s_and_b32 s63, s58, 1
    s_lshl_b32 s63, s63, 4
    s_mov_b32 s78, 1
    s_branch G1R3_done
G1R3_n4:
    s_cmp_ge_u32 s57, 2
    s_cbranch_scc0 G1R3_done
    s_cmp_eq_u32 s50, 1
    s_cbranch_scc0 G1R3_done
    s_sub_u32 s59, s57, 1
    s_lshl_b32 s59, s59, 11
    s_lshl_b32 s61, s51, 7
    s_add_u32 s59, s59, s61
    s_mov_b32 s61, 2
    s_mov_b32 s62, 6144
G1R3_done:
    s_cmp_eq_u32 s61, 0
    s_cselect_b32 s24, s72, s74
    s_cselect_b32 s25, s73, s75
    s_cmp_eq_u32 s61, 2
    s_cselect_b32 s24, s68, s24
    s_cselect_b32 s25, s69, s25
    s_and_b32 s25, s25, 0xffff
    s_lshl_b32 s26, s62, 10
    s_mov_b32 s27, 0x20000
    s_lshl_b32 s56, s56, 5
    s_add_u32 s56, s56, s63
    s_mul_i32 s56, s56, s62
    s_add_u32 s35, s56, s59
    s_lshl_b32 s40, s62, 6
    s_sub_u32 s35, s35, s40
    v_mul_lo_u32 v22, v18, s62
    s_and_b32 s56, s58, 1
    s_lshl_b32 s56, s56, 2
    v_xor_b32 v23, s56, v19
    v_lshl_add_u32 v22, v23, 4, v22
    s_cmp_eq_u32 s78, 1
    s_cselect_b64 vcc, -1, 0
    v_cndmask_b32 v14, v22, v21, vcc
    s_add_u32 s55, s3, 32
    s_cmp_ge_u32 s55, 20
    s_cselect_b32 s56, 1, 0
    s_mul_i32 s57, s56, 20
    s_sub_u32 s55, s55, s57
    s_lshr_b32 s57, s55, 2
    s_and_b32 s58, s55, 3
    s_lshl_b32 s59, s51, 1
    s_lshr_b32 s61, s57, 1
    s_add_u32 s59, s59, s61
    s_add_u32 s61, s51, 32
    s_cmp_eq_u32 s50, 0
    s_cselect_b32 s59, s59, s61
    s_lshl_b32 s59, s59, 7
    s_and_b32 s61, s57, 1
    s_mov_b32 s62, 7168
    s_lshl_b32 s63, s58, 3
    s_mov_b32 s78, 0
    s_cmp_eq_u32 s57, 4
    s_cbranch_scc0 G1R4_n4
    s_cmp_eq_u32 s50, 0
    s_cbranch_scc0 G1R4_gu
    s_lshl_b32 s59, s51, 7
    s_mov_b32 s61, 2
    s_mov_b32 s62, 6144
    s_branch G1R4_done
G1R4_gu:
    s_lshl_b32 s59, s51, 6
    s_add_u32 s59, s59, 6144
    s_lshr_b32 s61, s58, 1
    s_and_b32 s63, s58, 1
    s_lshl_b32 s63, s63, 4
    s_mov_b32 s78, 1
    s_branch G1R4_done
G1R4_n4:
    s_cmp_ge_u32 s57, 2
    s_cbranch_scc0 G1R4_done
    s_cmp_eq_u32 s50, 1
    s_cbranch_scc0 G1R4_done
    s_sub_u32 s59, s57, 1
    s_lshl_b32 s59, s59, 11
    s_lshl_b32 s61, s51, 7
    s_add_u32 s59, s59, s61
    s_mov_b32 s61, 2
    s_mov_b32 s62, 6144
G1R4_done:
    s_cmp_eq_u32 s61, 0
    s_cselect_b32 s28, s72, s74
    s_cselect_b32 s29, s73, s75
    s_cmp_eq_u32 s61, 2
    s_cselect_b32 s28, s68, s28
    s_cselect_b32 s29, s69, s29
    s_and_b32 s29, s29, 0xffff
    s_lshl_b32 s30, s62, 10
    s_mov_b32 s31, 0x20000
    s_lshl_b32 s56, s56, 5
    s_add_u32 s56, s56, s63
    s_mul_i32 s56, s56, s62
    s_add_u32 s36, s56, s59
    s_lshl_b32 s41, s62, 6
    s_sub_u32 s36, s36, s41
    v_mul_lo_u32 v22, v18, s62
    s_and_b32 s56, s58, 1
    s_lshl_b32 s56, s56, 2
    v_xor_b32 v23, s56, v19
    v_lshl_add_u32 v22, v23, 4, v22
    s_cmp_eq_u32 s78, 1
    s_cselect_b64 vcc, -1, 0
    v_cndmask_b32 v15, v22, v21, vcc
    v_lshrrev_b32 v18, 4, v17
    v_and_b32 v16, 15, v17
    v_lshlrev_b32 v16, 1, v16
    v_lshl_add_u32 v16, v18, 8, v16
    s_lshl_b32 s55, s51, 1
    s_add_u32 s55, s55, s53
    s_lshl_b32 s55, s55, 11
    buffer_load_ushort v80, v16, s[92:95], s55 offen offset:0
    buffer_load_ushort v81, v16, s[92:95], s55 offen offset:64
    buffer_load_ushort v82, v16, s[92:95], s55 offen offset:128
    buffer_load_ushort v83, v16, s[92:95], s55 offen offset:192
    buffer_load_ushort v84, v16, s[92:95], s55 offen offset:1024
    buffer_load_ushort v85, v16, s[92:95], s55 offen offset:1088
    buffer_load_ushort v86, v16, s[92:95], s55 offen offset:1152
    buffer_load_ushort v87, v16, s[92:95], s55 offen offset:1216
    buffer_load_ushort v88, v16, s[92:95], s55 offen offset:32
    buffer_load_ushort v89, v16, s[92:95], s55 offen offset:96
    buffer_load_ushort v90, v16, s[92:95], s55 offen offset:160
    buffer_load_ushort v91, v16, s[92:95], s55 offen offset:224
    buffer_load_ushort v92, v16, s[92:95], s55 offen offset:1056
    buffer_load_ushort v93, v16, s[92:95], s55 offen offset:1120
    buffer_load_ushort v94, v16, s[92:95], s55 offen offset:1184
    buffer_load_ushort v95, v16, s[92:95], s55 offen offset:1248
    s_add_u32 m0, s44, 0
    s_add_u32 s32, s32, s37
    buffer_load_dwordx4 v11, s[12:15], s32 offen sc1 lds
    s_add_u32 m0, s44, 8192
    s_add_u32 s33, s33, s38
    buffer_load_dwordx4 v12, s[16:19], s33 offen sc1 lds
    s_add_u32 m0, s44, 16384
    s_add_u32 s34, s34, s39
    buffer_load_dwordx4 v13, s[20:23], s34 offen sc1 lds
    s_add_u32 m0, s44, 24576
    s_add_u32 s35, s35, s40
    buffer_load_dwordx4 v14, s[24:27], s35 offen sc1 lds
    s_add_u32 m0, s44, 32768
    s_add_u32 s36, s36, s41
    buffer_load_dwordx4 v15, s[28:31], s36 offen sc1 lds
    s_add_u32 m0, s44, 40960
    s_add_u32 s32, s32, s37
    buffer_load_dwordx4 v11, s[12:15], s32 offen sc1 lds
    s_add_u32 m0, s44, 49152
    s_add_u32 s33, s33, s38
    buffer_load_dwordx4 v12, s[16:19], s33 offen sc1 lds
    s_cmp_eq_u32 s3, 5
    s_cselect_b32 s96, s74, s72
    s_cselect_b32 s97, s75, s73
    s_cmp_eq_u32 s3, 6
    s_cselect_b32 s96, s68, s96
    s_cselect_b32 s97, s69, s97
    s_cselect_b32 s55, 24, 28
    s_lshl_b32 s98, s55, 18
    s_cmp_eq_u32 s3, 7
    s_cselect_b32 s96, s6, s96
    s_cselect_b32 s97, s7, s97
    s_cselect_b32 s55, 32, s55
    s_cmp_eq_u32 s3, 3
    s_cselect_b32 s96, s4, s96
    s_cselect_b32 s97, s5, s97
    s_cselect_b32 s55, 10, s55
    s_cselect_b32 s98, 0x200000, s98
    s_and_b32 s97, s97, 0xffff
    s_mov_b32 s99, 0x20000
    s_lshl_b32 s101, s55, 15
    s_mul_i32 s100, s55, s2
    s_lshl_b32 s100, s100, 7
    s_sub_u32 s100, s100, s101
    v_lshlrev_b32 v72, 7, v17
    v_mov_b32 v16, 0x7f000000
    v_cmp_gt_u32 vcc, s55, v17
    s_nop 1
    v_cndmask_b32 v72, v16, v72, vcc
    s_lshl_b32 s55, s52, 12
    v_lshlrev_b32 v1, 4, v17
    v_add_u32 v1, s55, v1
    v_lshrrev_b32 v19, 2, v17
    v_and_b32 v19, 3, v19
    v_and_b32 v20, 3, v17
    v_and_b32 v21, 2, v19
    v_and_b32 v22, 1, v18
    v_lshlrev_b32 v22, 2, v22
    v_or_b32 v21, v21, v22
    v_lshrrev_b32 v22, 1, v20
    s_lshl_b32 s55, s53, 2
    v_add_u32 v22, s55, v22
    v_and_b32 v23, 1, v20
    v_lshlrev_b32 v23, 3, v23
    v_lshl_add_u32 v23, v18, 10, v23
    v_lshl_add_u32 v23, v19, 7, v23
    v_add_u32 v23, 65536, v23
    v_add_u32 v16, 0, v22
    v_xor_b32 v16, v16, v21
    v_lshl_add_u32 v2, v16, 4, v23
    v_add_u32 v4, 61440, v2
    v_add_u32 v16, 2, v22
    v_xor_b32 v16, v16, v21
    v_lshl_add_u32 v3, v16, 4, v23
    v_add_u32 v5, 61440, v3
    v_lshrrev_b32 v22, 1, v20
    s_lshl_b32 s55, s53, 1
    v_add_u32 v22, s55, v22
    v_and_b32 v21, 1, v18
    v_lshlrev_b32 v16, 1, v21
    v_xor_b32 v22, v22, v16
    v_and_b32 v23, 1, v20
    v_lshlrev_b32 v23, 3, v23
    v_lshl_add_u32 v23, v22, 4, v23
    v_lshl_add_u32 v23, v19, 6, v23
    v_lshl_add_u32 v23, v21, 8, v23
    v_lshrrev_b32 v16, 1, v18
    v_lshl_add_u32 v23, v16, 10, v23
    v_add_u32 v23, 65536, v23
    s_cmp_eq_u32 s50, 1
    s_cselect_b64 vcc, -1, 0
    v_add_u32 v16, 0, v23
    v_cndmask_b32 v6, v2, v16, vcc
    v_add_u32 v8, 61440, v6
    v_add_u32 v16, 2048, v23
    v_cndmask_b32 v7, v3, v16, vcc
    v_add_u32 v9, 61440, v7
    s_cmp_lt_u32 s3, 4
    s_cbranch_scc1 G1_ln
    s_cmp_eq_u32 s3, 7
    s_cbranch_scc1 G1_nopf0
    s_add_u32 s100, s100, s101
    buffer_load_dword v73, v72, s[96:99], s100 offen
    buffer_load_dword v73, v72, s[96:99], s100 offen offset:64
    s_add_u32 s100, s100, s101
    buffer_load_dword v73, v72, s[96:99], s100 offen
    buffer_load_dword v73, v72, s[96:99], s100 offen offset:64
G1_nopf0:
    v_mov_b32 v96, 0
    v_mov_b32 v97, 0
    v_mov_b32 v98, 0
    v_mov_b32 v99, 0
    v_mov_b32 v100, 0
    v_mov_b32 v101, 0
    v_mov_b32 v102, 0
    v_mov_b32 v103, 0
    v_mov_b32 v104, 0
    v_mov_b32 v105, 0
    v_mov_b32 v106, 0
    v_mov_b32 v107, 0
    v_mov_b32 v108, 0
    v_mov_b32 v109, 0
    v_mov_b32 v110, 0
    v_mov_b32 v111, 0
    v_mov_b32 v112, 0
    v_mov_b32 v113, 0
    v_mov_b32 v114, 0
    v_mov_b32 v115, 0
    v_mov_b32 v116, 0
    v_mov_b32 v117, 0
    v_mov_b32 v118, 0
    v_mov_b32 v119, 0
    v_mov_b32 v120, 0
    v_mov_b32 v121, 0
    v_mov_b32 v122, 0
    v_mov_b32 v123, 0
    v_mov_b32 v124, 0
    v_mov_b32 v125, 0
    v_mov_b32 v126, 0
    v_mov_b32 v127, 0
    v_mov_b32 v128, 0
    v_mov_b32 v129, 0
    v_mov_b32 v130, 0
    v_mov_b32 v131, 0
    v_mov_b32 v132, 0
    v_mov_b32 v133, 0
    v_mov_b32 v134, 0
    v_mov_b32 v135, 0
    v_mov_b32 v136, 0
    v_mov_b32 v137, 0
    v_mov_b32 v138, 0
    v_mov_b32 v139, 0
    v_mov_b32 v140, 0
    v_mov_b32 v141, 0
    v_mov_b32 v142, 0
    v_mov_b32 v143, 0
    v_mov_b32 v144, 0
    v_mov_b32 v145, 0
    v_mov_b32 v146, 0
    v_mov_b32 v147, 0
    v_mov_b32 v148, 0
    v_mov_b32 v149, 0
    v_mov_b32 v150, 0
    v_mov_b32 v151, 0
    v_mov_b32 v152, 0
    v_mov_b32 v153, 0
    v_mov_b32 v154, 0
    v_mov_b32 v155, 0
    v_mov_b32 v156, 0
    v_mov_b32 v157, 0
    v_mov_b32 v158, 0
    v_mov_b32 v159, 0
    v_mov_b32 v160, 0
    v_mov_b32 v161, 0
    v_mov_b32 v162, 0
    v_mov_b32 v163, 0
    v_mov_b32 v164, 0
    v_mov_b32 v165, 0
    v_mov_b32 v166, 0
    v_mov_b32 v167, 0
    v_mov_b32 v168, 0
    v_mov_b32 v169, 0
    v_mov_b32 v170, 0
    v_mov_b32 v171, 0
    v_mov_b32 v172, 0
    v_mov_b32 v173, 0
    v_mov_b32 v174, 0
    v_mov_b32 v175, 0
    v_mov_b32 v176, 0
    v_mov_b32 v177, 0
    v_mov_b32 v178, 0
    v_mov_b32 v179, 0
    v_mov_b32 v180, 0
    v_mov_b32 v181, 0
    v_mov_b32 v182, 0
    v_mov_b32 v183, 0
    v_mov_b32 v184, 0
    v_mov_b32 v185, 0
    v_mov_b32 v186, 0
    v_mov_b32 v187, 0
    v_mov_b32 v188, 0
    v_mov_b32 v189, 0
    v_mov_b32 v190, 0
    v_mov_b32 v191, 0
    v_mov_b32 v192, 0
    v_mov_b32 v193, 0
    v_mov_b32 v194, 0
    v_mov_b32 v195, 0
    v_mov_b32 v196, 0
    v_mov_b32 v197, 0
    v_mov_b32 v198, 0
    v_mov_b32 v199, 0
    v_mov_b32 v200, 0
    v_mov_b32 v201, 0
    v_mov_b32 v202, 0
    v_mov_b32 v203, 0
    v_mov_b32 v204, 0
    v_mov_b32 v205, 0
    v_mov_b32 v206, 0
    v_mov_b32 v207, 0
    v_mov_b32 v208, 0
    v_mov_b32 v209, 0
    v_mov_b32 v210, 0
    v_mov_b32 v211, 0
    v_mov_b32 v212, 0
    v_mov_b32 v213, 0
    v_mov_b32 v214, 0
    v_mov_b32 v215, 0
    v_mov_b32 v216, 0
    v_mov_b32 v217, 0
    v_mov_b32 v218, 0
    v_mov_b32 v219, 0
    v_mov_b32 v220, 0
    v_mov_b32 v221, 0
    v_mov_b32 v222, 0
    v_mov_b32 v223, 0
    v_mov_b32 v224, 0
    v_mov_b32 v225, 0
    v_mov_b32 v226, 0
    v_mov_b32 v227, 0
    v_mov_b32 v228, 0
    v_mov_b32 v229, 0
    v_mov_b32 v230, 0
    v_mov_b32 v231, 0
    v_mov_b32 v232, 0
    v_mov_b32 v233, 0
    v_mov_b32 v234, 0
    v_mov_b32 v235, 0
    v_mov_b32 v236, 0
    v_mov_b32 v237, 0
    v_mov_b32 v238, 0
    v_mov_b32 v239, 0
    v_mov_b32 v240, 0
    v_mov_b32 v241, 0
    v_mov_b32 v242, 0
    v_mov_b32 v243, 0
    v_mov_b32 v244, 0
    v_mov_b32 v245, 0
    v_mov_b32 v246, 0
    v_mov_b32 v247, 0
    v_mov_b32 v248, 0
    v_mov_b32 v249, 0
    v_mov_b32 v250, 0
    v_mov_b32 v251, 0
    v_mov_b32 v252, 0
    v_mov_b32 v253, 0
    v_mov_b32 v254, 0
    v_mov_b32 v255, 0
    s_barrier
    s_barrier
    s_branch G1_go
G1_ln:
    v_lshlrev_b32 v51, 4, v48
    v_add_u32 v51, 49152, v51
    v_lshrrev_b32 v52, 6, v0
    v_lshl_add_u32 v52, v52, 2, v51
    v_lshrrev_b32 v58, 4, v17
    v_and_b32 v58, 1, v58
    v_lshl_add_u32 v52, v58, 7, v52
    v_lshrrev_b32 v53, 2, v49
    s_lshl_b32 s55, s3, 3
    v_add_u32 v53, s55, v53
    v_lshlrev_b32 v53, 14, v53
    v_and_b32 v54, 3, v49
    v_lshl_add_u32 v53, v54, 8, v53
    v_lshl_add_u32 v53, v48, 4, v53
    s_lshr_b32 s55, s2, 5
    s_lshl_b32 s55, s55, 19
    s_lshr_b32 s56, s2, 1
    s_and_b32 s56, s56, 15
    s_lshl_b32 s56, s56, 10
    s_add_u32 s55, s55, s56
    s_and_b32 s56, s2, 1
    s_lshl_b32 s56, s56, 7
    s_add_u32 s55, s55, s56
    s_add_u32 s55, s55, 0
    s_waitcnt vmcnt(0)
    v_add_u32 v75, 1, v55
    v_or_b32 v75, 0x80000000, v75
    s_nop 0
    v_readfirstlane_b32 s79, v75
    v_lshlrev_b32 v112, 16, v96
    v_and_b32 v113, 0xffff0000, v96
    v_lshlrev_b32 v114, 16, v97
    v_and_b32 v115, 0xffff0000, v97
    v_lshlrev_b32 v116, 16, v98
    v_and_b32 v117, 0xffff0000, v98
    v_lshlrev_b32 v118, 16, v99
    v_and_b32 v119, 0xffff0000, v99
    v_lshlrev_b32 v120, 16, v100
    v_and_b32 v121, 0xffff0000, v100
    v_lshlrev_b32 v122, 16, v101
    v_and_b32 v123, 0xffff0000, v101
    v_lshlrev_b32 v124, 16, v102
    v_and_b32 v125, 0xffff0000, v102
    v_lshlrev_b32 v126, 16, v103
    v_and_b32 v127, 0xffff0000, v103
    v_lshlrev_b32 v128, 16, v104
    v_and_b32 v129, 0xffff0000, v104
    v_lshlrev_b32 v130, 16, v105
    v_and_b32 v131, 0xffff0000, v105
    v_lshlrev_b32 v132, 16, v106
    v_and_b32 v133, 0xffff0000, v106
    v_lshlrev_b32 v134, 16, v107
    v_and_b32 v135, 0xffff0000, v107
    v_lshlrev_b32 v136, 16, v108
    v_and_b32 v137, 0xffff0000, v108
    v_lshlrev_b32 v138, 16, v109
    v_and_b32 v139, 0xffff0000, v109
    v_lshlrev_b32 v140, 16, v110
    v_and_b32 v141, 0xffff0000, v110
    v_lshlrev_b32 v142, 16, v111
    v_and_b32 v143, 0xffff0000, v111
    v_lshlrev_b32 v47, 16, v47
    v_sub_f32 v144, v112, v47
    v_sub_f32 v145, v120, v47
    v_sub_f32 v146, v128, v47
    v_sub_f32 v147, v136, v47
    v_mul_f32 v148, v144, v144
    v_mul_f32 v149, v145, v145
    v_mul_f32 v150, v146, v146
    v_mul_f32 v151, v147, v147
    v_sub_f32 v152, v113, v47
    v_sub_f32 v153, v121, v47
    v_sub_f32 v154, v129, v47
    v_sub_f32 v155, v137, v47
    v_add_f32 v144, v144, v152
    v_fmac_f32 v148, v152, v152
    v_add_f32 v145, v145, v153
    v_fmac_f32 v149, v153, v153
    v_add_f32 v146, v146, v154
    v_fmac_f32 v150, v154, v154
    v_add_f32 v147, v147, v155
    v_fmac_f32 v151, v155, v155
    v_sub_f32 v152, v114, v47
    v_sub_f32 v153, v122, v47
    v_sub_f32 v154, v130, v47
    v_sub_f32 v155, v138, v47
    v_add_f32 v144, v144, v152
    v_fmac_f32 v148, v152, v152
    v_add_f32 v145, v145, v153
    v_fmac_f32 v149, v153, v153
    v_add_f32 v146, v146, v154
    v_fmac_f32 v150, v154, v154
    v_add_f32 v147, v147, v155
    v_fmac_f32 v151, v155, v155
    v_sub_f32 v152, v115, v47
    v_sub_f32 v153, v123, v47
    v_sub_f32 v154, v131, v47
    v_sub_f32 v155, v139, v47
    v_add_f32 v144, v144, v152
    v_fmac_f32 v148, v152, v152
    v_add_f32 v145, v145, v153
    v_fmac_f32 v149, v153, v153
    v_add_f32 v146, v146, v154
    v_fmac_f32 v150, v154, v154
    v_add_f32 v147, v147, v155
    v_fmac_f32 v151, v155, v155
    v_sub_f32 v152, v116, v47
    v_sub_f32 v153, v124, v47
    v_sub_f32 v154, v132, v47
    v_sub_f32 v155, v140, v47
    v_add_f32 v144, v144, v152
    v_fmac_f32 v148, v152, v152
    v_add_f32 v145, v145, v153
    v_fmac_f32 v149, v153, v153
    v_add_f32 v146, v146, v154
    v_fmac_f32 v150, v154, v154
    v_add_f32 v147, v147, v155
    v_fmac_f32 v151, v155, v155
    v_sub_f32 v152, v117, v47
    v_sub_f32 v153, v125, v47
    v_sub_f32 v154, v133, v47
    v_sub_f32 v155, v141, v47
    v_add_f32 v144, v144, v152
    v_fmac_f32 v148, v152, v152
    v_add_f32 v145, v145, v153
    v_fmac_f32 v149, v153, v153
    v_add_f32 v146, v146, v154
    v_fmac_f32 v150, v154, v154
    v_add_f32 v147, v147, v155
    v_fmac_f32 v151, v155, v155
    v_sub_f32 v152, v118, v47
    v_sub_f32 v153, v126, v47
    v_sub_f32 v154, v134, v47
    v_sub_f32 v155, v142, v47
    v_add_f32 v144, v144, v152
    v_fmac_f32 v148, v152, v152
    v_add_f32 v145, v145, v153
    v_fmac_f32 v149, v153, v153
    v_add_f32 v146, v146, v154
    v_fmac_f32 v150, v154, v154
    v_add_f32 v147, v147, v155
    v_fmac_f32 v151, v155, v155
    v_sub_f32 v152, v119, v47
    v_sub_f32 v153, v127, v47
    v_sub_f32 v154, v135, v47
    v_sub_f32 v155, v143, v47
    v_add_f32 v144, v144, v152
    v_fmac_f32 v148, v152, v152
    v_add_f32 v145, v145, v153
    v_fmac_f32 v149, v153, v153
    v_add_f32 v146, v146, v154
    v_fmac_f32 v150, v154, v154
    v_add_f32 v147, v147, v155
    v_fmac_f32 v151, v155, v155
    v_add_f32 v144, v144, v145
    v_add_f32 v146, v146, v147
    v_add_f32 v148, v148, v149
    v_add_f32 v150, v150, v151
    v_add_f32 v57, v144, v146
    v_add_f32 v59, v148, v150
    s_nop 0
    v_add_f32_dpp v57, v57, v57 row_ror:8 row_mask:0xf bank_mask:0xf
    v_add_f32_dpp v59, v59, v59 row_ror:8 row_mask:0xf bank_mask:0xf
    s_nop 1
    v_permlane16_swap_b32 v57, v59
    v_add_f32 v57, v57, v59
    v_mov_b32 v59, v57
    s_nop 1
    v_permlane32_swap_b32 v57, v59
    v_add_f32 v57, v57, v59
    ds_write_b32 v52, v57
    s_waitcnt lgkmcnt(0)
    s_barrier
    ds_read_b128 v[60:63], v51
    ds_read_b128 v[64:67], v51 offset:128
    s_waitcnt lgkmcnt(0)
    v_add_f32 v60, v60, v61
    v_add_f32 v62, v62, v63
    v_add_f32 v64, v64, v65
    v_add_f32 v66, v66, v67
    v_add_f32 v57, v60, v62
    v_add_f32 v59, v64, v66
    v_mul_f32 v57, 0x3a800000, v57
    v_mul_f32 v59, 0x3a800000, v59
    v_fma_f32 v59, -v57, v57, v59
    v_max_f32 v59, 0, v59
    v_add_f32 v57, v57, v47
    v_cvt_pk_bf16_f32 v58, v57, v59
    v_lshlrev_b32 v57, 16, v58
    v_and_b32 v59, 0xffff0000, v58
    v_add_f32 v59, 0x3727c5ac, v59
    v_cvt_pk_bf16_f32 v58, v59, v59
    v_lshlrev_b32 v59, 16, v58
    v_sqrt_f32 v59, v59
    s_nop 0
    v_cvt_pk_bf16_f32 v58, v59, v59
    v_lshlrev_b32 v59, 16, v58
    v_rcp_f32 v60, v59
    s_nop 0
    v_fma_f32 v61, -v59, v60, 1.0
    v_fma_f32 v60, v60, v61, v60
    v_sub_f32 v112, v112, v57
    v_sub_f32 v113, v113, v57
    v_sub_f32 v114, v114, v57
    v_sub_f32 v115, v115, v57
    v_sub_f32 v116, v116, v57
    v_sub_f32 v117, v117, v57
    v_sub_f32 v118, v118, v57
    v_sub_f32 v119, v119, v57
    v_cvt_pk_bf16_f32 v144, v112, v113
    v_lshlrev_b32 v112, 16, v144
    v_and_b32 v113, 0xffff0000, v144
    v_cvt_pk_bf16_f32 v145, v114, v115
    v_lshlrev_b32 v114, 16, v145
    v_and_b32 v115, 0xffff0000, v145
    v_cvt_pk_bf16_f32 v146, v116, v117
    v_lshlrev_b32 v116, 16, v146
    v_and_b32 v117, 0xffff0000, v146
    v_cvt_pk_bf16_f32 v147, v118, v119
    v_lshlrev_b32 v118, 16, v147
    v_and_b32 v119, 0xffff0000, v147
    v_mul_f32 v112, v112, v60
    v_mul_f32 v113, v113, v60
    v_mul_f32 v114, v114, v60
    v_mul_f32 v115, v115, v60
    v_mul_f32 v116, v116, v60
    v_mul_f32 v117, v117, v60
    v_mul_f32 v118, v118, v60
    v_mul_f32 v119, v119, v60
    v_cvt_pk_bf16_f32 v24, v112, v113
    v_cvt_pk_bf16_f32 v25, v114, v115
    v_cvt_pk_bf16_f32 v26, v116, v117
    v_cvt_pk_bf16_f32 v27, v118, v119
    buffer_store_dwordx4 v[24:27], v53, s[64:67], s55 offen sc1
    s_add_u32 s55, s55, 32768
    v_sub_f32 v120, v120, v57
    v_sub_f32 v121, v121, v57
    v_sub_f32 v122, v122, v57
    v_sub_f32 v123, v123, v57
    v_sub_f32 v124, v124, v57
    v_sub_f32 v125, v125, v57
    v_sub_f32 v126, v126, v57
    v_sub_f32 v127, v127, v57
    v_cvt_pk_bf16_f32 v144, v120, v121
    v_lshlrev_b32 v120, 16, v144
    v_and_b32 v121, 0xffff0000, v144
    v_cvt_pk_bf16_f32 v145, v122, v123
    v_lshlrev_b32 v122, 16, v145
    v_and_b32 v123, 0xffff0000, v145
    v_cvt_pk_bf16_f32 v146, v124, v125
    v_lshlrev_b32 v124, 16, v146
    v_and_b32 v125, 0xffff0000, v146
    v_cvt_pk_bf16_f32 v147, v126, v127
    v_lshlrev_b32 v126, 16, v147
    v_and_b32 v127, 0xffff0000, v147
    v_mul_f32 v120, v120, v60
    v_mul_f32 v121, v121, v60
    v_mul_f32 v122, v122, v60
    v_mul_f32 v123, v123, v60
    v_mul_f32 v124, v124, v60
    v_mul_f32 v125, v125, v60
    v_mul_f32 v126, v126, v60
    v_mul_f32 v127, v127, v60
    v_cvt_pk_bf16_f32 v28, v120, v121
    v_cvt_pk_bf16_f32 v29, v122, v123
    v_cvt_pk_bf16_f32 v30, v124, v125
    v_cvt_pk_bf16_f32 v31, v126, v127
    buffer_store_dwordx4 v[28:31], v53, s[64:67], s55 offen sc1
    s_add_u32 s55, s55, 32768
    v_sub_f32 v128, v128, v57
    v_sub_f32 v129, v129, v57
    v_sub_f32 v130, v130, v57
    v_sub_f32 v131, v131, v57
    v_sub_f32 v132, v132, v57
    v_sub_f32 v133, v133, v57
    v_sub_f32 v134, v134, v57
    v_sub_f32 v135, v135, v57
    v_cvt_pk_bf16_f32 v144, v128, v129
    v_lshlrev_b32 v128, 16, v144
    v_and_b32 v129, 0xffff0000, v144
    v_cvt_pk_bf16_f32 v145, v130, v131
    v_lshlrev_b32 v130, 16, v145
    v_and_b32 v131, 0xffff0000, v145
    v_cvt_pk_bf16_f32 v146, v132, v133
    v_lshlrev_b32 v132, 16, v146
    v_and_b32 v133, 0xffff0000, v146
    v_cvt_pk_bf16_f32 v147, v134, v135
    v_lshlrev_b32 v134, 16, v147
    v_and_b32 v135, 0xffff0000, v147
    v_mul_f32 v128, v128, v60
    v_mul_f32 v129, v129, v60
    v_mul_f32 v130, v130, v60
    v_mul_f32 v131, v131, v60
    v_mul_f32 v132, v132, v60
    v_mul_f32 v133, v133, v60
    v_mul_f32 v134, v134, v60
    v_mul_f32 v135, v135, v60
    v_cvt_pk_bf16_f32 v32, v128, v129
    v_cvt_pk_bf16_f32 v33, v130, v131
    v_cvt_pk_bf16_f32 v34, v132, v133
    v_cvt_pk_bf16_f32 v35, v134, v135
    buffer_store_dwordx4 v[32:35], v53, s[64:67], s55 offen sc1
    s_add_u32 s55, s55, 32768
    v_sub_f32 v136, v136, v57
    v_sub_f32 v137, v137, v57
    v_sub_f32 v138, v138, v57
    v_sub_f32 v139, v139, v57
    v_sub_f32 v140, v140, v57
    v_sub_f32 v141, v141, v57
    v_sub_f32 v142, v142, v57
    v_sub_f32 v143, v143, v57
    v_cvt_pk_bf16_f32 v144, v136, v137
    v_lshlrev_b32 v136, 16, v144
    v_and_b32 v137, 0xffff0000, v144
    v_cvt_pk_bf16_f32 v145, v138, v139
    v_lshlrev_b32 v138, 16, v145
    v_and_b32 v139, 0xffff0000, v145
    v_cvt_pk_bf16_f32 v146, v140, v141
    v_lshlrev_b32 v140, 16, v146
    v_and_b32 v141, 0xffff0000, v146
    v_cvt_pk_bf16_f32 v147, v142, v143
    v_lshlrev_b32 v142, 16, v147
    v_and_b32 v143, 0xffff0000, v147
    v_mul_f32 v136, v136, v60
    v_mul_f32 v137, v137, v60
    v_mul_f32 v138, v138, v60
    v_mul_f32 v139, v139, v60
    v_mul_f32 v140, v140, v60
    v_mul_f32 v141, v141, v60
    v_mul_f32 v142, v142, v60
    v_mul_f32 v143, v143, v60
    v_cvt_pk_bf16_f32 v36, v136, v137
    v_cvt_pk_bf16_f32 v37, v138, v139
    v_cvt_pk_bf16_f32 v38, v140, v141
    v_cvt_pk_bf16_f32 v39, v142, v143
    buffer_store_dwordx4 v[36:39], v53, s[64:67], s55 offen sc1
    v_mov_b32 v60, 0
    v_mov_b32 v61, 0
    v_mov_b32 v62, 0
    v_mov_b32 v63, 0
    v_lshlrev_b32 v59, 4, v0
    s_mul_i32 s55, s2, 1152
    s_add_u32 s55, s55, 50331648
    v_cmp_gt_u32 vcc, 72, v0
    s_nop 0
    s_and_saveexec_b64 s[58:59], vcc
    s_cbranch_execz G1_nz
    buffer_store_dwordx4 v[60:63], v59, s[64:67], s55 offen sc1
G1_nz:
    s_mov_b64 exec, s[58:59]
    s_waitcnt vmcnt(0)
    s_barrier
    s_cmp_lg_u32 s3, 0
    s_cbranch_scc1 G1_nfs
    s_lshl_b32 s55, s2, 6
    s_add_u32 s55, s55, 58785792
    s_mov_b64 exec, 1
    buffer_store_dword v75, v60, s[64:67], s55 offen sc1
    s_mov_b64 exec, -1
G1_nfs:
    v_mov_b32 v96, 0
    v_mov_b32 v97, 0
    v_mov_b32 v98, 0
    v_mov_b32 v99, 0
    v_mov_b32 v100, 0
    v_mov_b32 v101, 0
    v_mov_b32 v102, 0
    v_mov_b32 v103, 0
    v_mov_b32 v104, 0
    v_mov_b32 v105, 0
    v_mov_b32 v106, 0
    v_mov_b32 v107, 0
    v_mov_b32 v108, 0
    v_mov_b32 v109, 0
    v_mov_b32 v110, 0
    v_mov_b32 v111, 0
    v_mov_b32 v112, 0
    v_mov_b32 v113, 0
    v_mov_b32 v114, 0
    v_mov_b32 v115, 0
    v_mov_b32 v116, 0
    v_mov_b32 v117, 0
    v_mov_b32 v118, 0
    v_mov_b32 v119, 0
    v_mov_b32 v120, 0
    v_mov_b32 v121, 0
    v_mov_b32 v122, 0
    v_mov_b32 v123, 0
    v_mov_b32 v124, 0
    v_mov_b32 v125, 0
    v_mov_b32 v126, 0
    v_mov_b32 v127, 0
    v_mov_b32 v128, 0
    v_mov_b32 v129, 0
    v_mov_b32 v130, 0
    v_mov_b32 v131, 0
    v_mov_b32 v132, 0
    v_mov_b32 v133, 0
    v_mov_b32 v134, 0
    v_mov_b32 v135, 0
    v_mov_b32 v136, 0
    v_mov_b32 v137, 0
    v_mov_b32 v138, 0
    v_mov_b32 v139, 0
    v_mov_b32 v140, 0
    v_mov_b32 v141, 0
    v_mov_b32 v142, 0
    v_mov_b32 v143, 0
    v_mov_b32 v144, 0
    v_mov_b32 v145, 0
    v_mov_b32 v146, 0
    v_mov_b32 v147, 0
    v_mov_b32 v148, 0
    v_mov_b32 v149, 0
    v_mov_b32 v150, 0
    v_mov_b32 v151, 0
    v_mov_b32 v152, 0
    v_mov_b32 v153, 0
    v_mov_b32 v154, 0
    v_mov_b32 v155, 0
    v_mov_b32 v156, 0
    v_mov_b32 v157, 0
    v_mov_b32 v158, 0
    v_mov_b32 v159, 0
    v_mov_b32 v160, 0
    v_mov_b32 v161, 0
    v_mov_b32 v162, 0
    v_mov_b32 v163, 0
    v_mov_b32 v164, 0
    v_mov_b32 v165, 0
    v_mov_b32 v166, 0
    v_mov_b32 v167, 0
    v_mov_b32 v168, 0
    v_mov_b32 v169, 0
    v_mov_b32 v170, 0
    v_mov_b32 v171, 0
    v_mov_b32 v172, 0
    v_mov_b32 v173, 0
    v_mov_b32 v174, 0
    v_mov_b32 v175, 0
    v_mov_b32 v176, 0
    v_mov_b32 v177, 0
    v_mov_b32 v178, 0
    v_mov_b32 v179, 0
    v_mov_b32 v180, 0
    v_mov_b32 v181, 0
    v_mov_b32 v182, 0
    v_mov_b32 v183, 0
    v_mov_b32 v184, 0
    v_mov_b32 v185, 0
    v_mov_b32 v186, 0
    v_mov_b32 v187, 0
    v_mov_b32 v188, 0
    v_mov_b32 v189, 0
    v_mov_b32 v190, 0
    v_mov_b32 v191, 0
    v_mov_b32 v192, 0
    v_mov_b32 v193, 0
    v_mov_b32 v194, 0
    v_mov_b32 v195, 0
    v_mov_b32 v196, 0
    v_mov_b32 v197, 0
    v_mov_b32 v198, 0
    v_mov_b32 v199, 0
    v_mov_b32 v200, 0
    v_mov_b32 v201, 0
    v_mov_b32 v202, 0
    v_mov_b32 v203, 0
    v_mov_b32 v204, 0
    v_mov_b32 v205, 0
    v_mov_b32 v206, 0
    v_mov_b32 v207, 0
    v_mov_b32 v208, 0
    v_mov_b32 v209, 0
    v_mov_b32 v210, 0
    v_mov_b32 v211, 0
    v_mov_b32 v212, 0
    v_mov_b32 v213, 0
    v_mov_b32 v214, 0
    v_mov_b32 v215, 0
    v_mov_b32 v216, 0
    v_mov_b32 v217, 0
    v_mov_b32 v218, 0
    v_mov_b32 v219, 0
    v_mov_b32 v220, 0
    v_mov_b32 v221, 0
    v_mov_b32 v222, 0
    v_mov_b32 v223, 0
    v_mov_b32 v224, 0
    v_mov_b32 v225, 0
    v_mov_b32 v226, 0
    v_mov_b32 v227, 0
    v_mov_b32 v228, 0
    v_mov_b32 v229, 0
    v_mov_b32 v230, 0
    v_mov_b32 v231, 0
    v_mov_b32 v232, 0
    v_mov_b32 v233, 0
    v_mov_b32 v234, 0
    v_mov_b32 v235, 0
    v_mov_b32 v236, 0
    v_mov_b32 v237, 0
    v_mov_b32 v238, 0
    v_mov_b32 v239, 0
    v_mov_b32 v240, 0
    v_mov_b32 v241, 0
    v_mov_b32 v242, 0
    v_mov_b32 v243, 0
    v_mov_b32 v244, 0
    v_mov_b32 v245, 0
    v_mov_b32 v246, 0
    v_mov_b32 v247, 0
    v_mov_b32 v248, 0
    v_mov_b32 v249, 0
    v_mov_b32 v250, 0
    v_mov_b32 v251, 0
    v_mov_b32 v252, 0
    v_mov_b32 v253, 0
    v_mov_b32 v254, 0
    v_mov_b32 v255, 0
    s_cmp_lg_u32 s3, 0
    s_cbranch_scc1 G1_go
    v_and_b32 v61, 31, v17
    s_lshl_b32 s55, s47, 5
    v_add_u32 v61, s55, v61
    v_and_b32 v62, 15, v17
    s_lshl_b32 s55, s51, 4
    v_add_u32 v62, s55, v62
    v_cmp_gt_u32 vcc, 32, v17
    s_nop 1
    v_cndmask_b32 v62, v62, v61, vcc
    v_lshlrev_b32 v62, 6, v62
    s_mov_b32 s57, 58785792
    s_mov_b32 s55, 0
G1_poll:
    buffer_load_dword v63, v62, s[64:67], s57 offen sc1
    s_waitcnt vmcnt(0)
    v_cmp_eq_u32 vcc, v75, v63
    s_nop 0
    s_cmp_eq_u64 vcc, -1
    s_cbranch_scc1 G1_go
    s_sleep 1
    s_add_u32 s55, s55, 1
    s_cmp_lt_u32 s55, 0x100000
    s_cbranch_scc1 G1_poll
G1_go:
    s_barrier
    s_add_u32 m0, s43, 0
    s_add_u32 s42, s42, 8192
    buffer_load_dwordx4 v10, s[8:11], s42 offen sc1 lds
    s_add_u32 m0, s43, 8192
    s_add_u32 s42, s42, 8192
    buffer_load_dwordx4 v10, s[8:11], s42 offen sc1 lds
    s_add_u32 m0, s43, 16384
    s_add_u32 s42, s42, 8192
    buffer_load_dwordx4 v10, s[8:11], s42 offen sc1 lds
    s_add_u32 m0, s43, 24576
    s_add_u32 s42, s42, 8192
    buffer_load_dwordx4 v10, s[8:11], s42 offen sc1 lds
    s_add_u32 m0, s43, 32768
    s_add_u32 s42, s42, 8192
    buffer_load_dwordx4 v10, s[8:11], s42 offen sc1 lds
    s_add_u32 m0, s43, 40960
    s_add_u32 s42, s42, 8192
    buffer_load_dwordx4 v10, s[8:11], s42 offen sc1 lds
    s_waitcnt vmcnt(0)
    s_barrier
    ds_read_b64_tr_b16 v[56:57], v2 offset:0
    ds_read_b64_tr_b16 v[58:59], v2 offset:512
    ds_read_b128 v[24:27], v1 offset:0
    ds_read_b128 v[28:31], v1 offset:1024
    s_add_u32 m0, s44, 57344
    s_add_u32 s34, s34, s39
    buffer_load_dwordx4 v13, s[20:23], s34 offen sc1 lds
    ds_read_b64_tr_b16 v[60:61], v3 offset:0
    ds_read_b64_tr_b16 v[62:63], v3 offset:512
    ds_read_b128 v[32:35], v1 offset:2048
    ds_read_b128 v[36:39], v1 offset:3072
    s_add_u32 m0, s43, 49152
    s_add_u32 s42, s42, 8192
    buffer_load_dwordx4 v10, s[8:11], s42 offen sc1 lds
    ds_read_b64_tr_b16 v[64:65], v2 offset:4096
    ds_read_b64_tr_b16 v[66:67], v2 offset:4608
    s_add_u32 m0, s44, 65536
    s_add_u32 s35, s35, s40
    buffer_load_dwordx4 v14, s[24:27], s35 offen sc1 lds
    s_mov_b32 s60, 7
.p2align 6
G1_loop:
    s_cmp_lt_u32 s3, 3
    s_cbranch_scc1 G1_nopfl
    s_add_u32 s100, s100, s101
    buffer_load_dword v73, v72, s[96:99], s100 offen
    buffer_load_dword v73, v72, s[96:99], s100 offen offset:64
G1_nopfl:
    s_waitcnt lgkmcnt(2)
    v_mfma_f32_16x16x32_bf16 v[96:99], v[56:59], v[24:27], v[96:99]
    ds_read_b64_tr_b16 v[68:69], v3 offset:4096
    v_mfma_f32_16x16x32_bf16 v[100:103], v[56:59], v[28:31], v[100:103]
    ds_read_b64_tr_b16 v[70:71], v3 offset:4608
    v_mfma_f32_16x16x32_bf16 v[104:107], v[56:59], v[32:35], v[104:107]
    s_add_u32 m0, s43, 57344
    s_add_u32 s42, s42, 8192
    buffer_load_dwordx4 v10, s[8:11], s42 offen sc1 lds
    v_mfma_f32_16x16x32_bf16 v[108:111], v[56:59], v[36:39], v[108:111]
    v_mfma_f32_16x16x32_bf16 v[124:127], v[60:63], v[36:39], v[124:127]
    ds_read_b64_tr_b16 v[56:57], v2 offset:8192
    v_mfma_f32_16x16x32_bf16 v[120:123], v[60:63], v[32:35], v[120:123]
    ds_read_b64_tr_b16 v[58:59], v2 offset:8704
    v_mfma_f32_16x16x32_bf16 v[116:119], v[60:63], v[28:31], v[116:119]
    s_add_u32 m0, s44, 73728
    s_add_u32 s36, s36, s41
    buffer_load_dwordx4 v15, s[28:31], s36 offen sc1 lds
    v_mfma_f32_16x16x32_bf16 v[112:115], v[60:63], v[24:27], v[112:115]
    s_waitcnt lgkmcnt(4)
    v_mfma_f32_16x16x32_bf16 v[128:131], v[64:67], v[24:27], v[128:131]
    ds_read_b64_tr_b16 v[60:61], v3 offset:8192
    v_mfma_f32_16x16x32_bf16 v[132:135], v[64:67], v[28:31], v[132:135]
    ds_read_b64_tr_b16 v[62:63], v3 offset:8704
    v_mfma_f32_16x16x32_bf16 v[136:139], v[64:67], v[32:35], v[136:139]
    v_mfma_f32_16x16x32_bf16 v[140:143], v[64:67], v[36:39], v[140:143]
    s_waitcnt lgkmcnt(4)
    v_mfma_f32_16x16x32_bf16 v[156:159], v[68:71], v[36:39], v[156:159]
    ds_read_b64_tr_b16 v[64:65], v2 offset:12288
    v_mfma_f32_16x16x32_bf16 v[152:155], v[68:71], v[32:35], v[152:155]
    ds_read_b64_tr_b16 v[66:67], v2 offset:12800
    v_mfma_f32_16x16x32_bf16 v[148:151], v[68:71], v[28:31], v[148:151]
    v_mfma_f32_16x16x32_bf16 v[144:147], v[68:71], v[24:27], v[144:147]
    s_waitcnt lgkmcnt(4)
    v_mfma_f32_16x16x32_bf16 v[160:163], v[56:59], v[24:27], v[160:163]
    ds_read_b64_tr_b16 v[68:69], v3 offset:12288
    v_mfma_f32_16x16x32_bf16 v[164:167], v[56:59], v[28:31], v[164:167]
    ds_read_b64_tr_b16 v[70:71], v3 offset:12800
    v_mfma_f32_16x16x32_bf16 v[168:171], v[56:59], v[32:35], v[168:171]
    v_mfma_f32_16x16x32_bf16 v[172:175], v[56:59], v[36:39], v[172:175]
    s_waitcnt lgkmcnt(4)
    v_mfma_f32_16x16x32_bf16 v[188:191], v[60:63], v[36:39], v[188:191]
    ds_read_b64_tr_b16 v[56:57], v6 offset:16384
    v_mfma_f32_16x16x32_bf16 v[184:187], v[60:63], v[32:35], v[184:187]
    ds_read_b64_tr_b16 v[58:59], v6 offset:16896
    v_mfma_f32_16x16x32_bf16 v[180:183], v[60:63], v[28:31], v[180:183]
    v_mfma_f32_16x16x32_bf16 v[176:179], v[60:63], v[24:27], v[176:179]
    s_waitcnt lgkmcnt(4)
    v_mfma_f32_16x16x32_bf16 v[192:195], v[64:67], v[24:27], v[192:195]
    ds_read_b64_tr_b16 v[60:61], v7 offset:16384
    v_mfma_f32_16x16x32_bf16 v[196:199], v[64:67], v[28:31], v[196:199]
    ds_read_b64_tr_b16 v[62:63], v7 offset:16896
    v_mfma_f32_16x16x32_bf16 v[200:203], v[64:67], v[32:35], v[200:203]
    v_mfma_f32_16x16x32_bf16 v[204:207], v[64:67], v[36:39], v[204:207]
    s_waitcnt lgkmcnt(0) vmcnt(9)
    s_barrier
    v_mfma_f32_16x16x32_bf16 v[220:223], v[68:71], v[36:39], v[220:223]
    ds_read_b64_tr_b16 v[64:65], v2 offset:20480
    ds_read_b64_tr_b16 v[66:67], v2 offset:20992
    v_mfma_f32_16x16x32_bf16 v[216:219], v[68:71], v[32:35], v[216:219]
    ds_read_b128 v[40:43], v1 offset:16384
    v_mfma_f32_16x16x32_bf16 v[212:215], v[68:71], v[28:31], v[212:215]
    ds_read_b128 v[44:47], v1 offset:17408
    v_mfma_f32_16x16x32_bf16 v[208:211], v[68:71], v[24:27], v[208:211]
    s_add_u32 m0, s43, 0
    s_add_u32 s42, s42, 8192
    buffer_load_dwordx4 v10, s[8:11], s42 offen sc1 lds
    v_mfma_f32_16x16x32_bf16 v[224:227], v[56:59], v[24:27], v[224:227]
    ds_read_b64_tr_b16 v[68:69], v3 offset:20480
    ds_read_b64_tr_b16 v[70:71], v3 offset:20992
    v_mfma_f32_16x16x32_bf16 v[228:231], v[56:59], v[28:31], v[228:231]
    ds_read_b128 v[48:51], v1 offset:18432
    v_mfma_f32_16x16x32_bf16 v[232:235], v[56:59], v[32:35], v[232:235]
    ds_read_b128 v[52:55], v1 offset:19456
    v_mfma_f32_16x16x32_bf16 v[236:239], v[56:59], v[36:39], v[236:239]
    s_add_u32 m0, s44, 0
    s_add_u32 s32, s32, s37
    buffer_load_dwordx4 v11, s[12:15], s32 offen sc1 lds
    v_mfma_f32_16x16x32_bf16 v[252:255], v[60:63], v[36:39], v[252:255]
    ds_read_b64_tr_b16 v[56:57], v2 offset:24576
    v_mfma_f32_16x16x32_bf16 v[248:251], v[60:63], v[32:35], v[248:251]
    ds_read_b64_tr_b16 v[58:59], v2 offset:25088
    v_mfma_f32_16x16x32_bf16 v[244:247], v[60:63], v[28:31], v[244:247]
    s_add_u32 m0, s43, 8192
    s_add_u32 s42, s42, 8192
    buffer_load_dwordx4 v10, s[8:11], s42 offen sc1 lds
    v_mfma_f32_16x16x32_bf16 v[240:243], v[60:63], v[24:27], v[240:243]
    s_waitcnt lgkmcnt(2)
    v_mfma_f32_16x16x32_bf16 v[96:99], v[64:67], v[40:43], v[96:99]
    ds_read_b64_tr_b16 v[60:61], v3 offset:24576
    v_mfma_f32_16x16x32_bf16 v[100:103], v[64:67], v[44:47], v[100:103]
    ds_read_b64_tr_b16 v[62:63], v3 offset:25088
    v_mfma_f32_16x16x32_bf16 v[104:107], v[64:67], v[48:51], v[104:107]
    s_add_u32 m0, s44, 8192
    s_add_u32 s33, s33, s38
    buffer_load_dwordx4 v12, s[16:19], s33 offen sc1 lds
    v_mfma_f32_16x16x32_bf16 v[108:111], v[64:67], v[52:55], v[108:111]
    v_mfma_f32_16x16x32_bf16 v[124:127], v[68:71], v[52:55], v[124:127]
    ds_read_b64_tr_b16 v[64:65], v2 offset:28672
    v_mfma_f32_16x16x32_bf16 v[120:123], v[68:71], v[48:51], v[120:123]
    ds_read_b64_tr_b16 v[66:67], v2 offset:29184
    v_mfma_f32_16x16x32_bf16 v[116:119], v[68:71], v[44:47], v[116:119]
    v_mfma_f32_16x16x32_bf16 v[112:115], v[68:71], v[40:43], v[112:115]
    s_waitcnt lgkmcnt(4)
    v_mfma_f32_16x16x32_bf16 v[128:131], v[56:59], v[40:43], v[128:131]
    ds_read_b64_tr_b16 v[68:69], v3 offset:28672
    v_mfma_f32_16x16x32_bf16 v[132:135], v[56:59], v[44:47], v[132:135]
    ds_read_b64_tr_b16 v[70:71], v3 offset:29184
    v_mfma_f32_16x16x32_bf16 v[136:139], v[56:59], v[48:51], v[136:139]
    v_mfma_f32_16x16x32_bf16 v[140:143], v[56:59], v[52:55], v[140:143]
    s_waitcnt lgkmcnt(4)
    v_mfma_f32_16x16x32_bf16 v[156:159], v[60:63], v[52:55], v[156:159]
    ds_read_b64_tr_b16 v[56:57], v2 offset:32768
    v_mfma_f32_16x16x32_bf16 v[152:155], v[60:63], v[48:51], v[152:155]
    ds_read_b64_tr_b16 v[58:59], v2 offset:33280
    v_mfma_f32_16x16x32_bf16 v[148:151], v[60:63], v[44:47], v[148:151]
    v_mfma_f32_16x16x32_bf16 v[144:147], v[60:63], v[40:43], v[144:147]
    s_waitcnt lgkmcnt(4)
    v_mfma_f32_16x16x32_bf16 v[160:163], v[64:67], v[40:43], v[160:163]
    ds_read_b64_tr_b16 v[60:61], v3 offset:32768
    v_mfma_f32_16x16x32_bf16 v[164:167], v[64:67], v[44:47], v[164:167]
    ds_read_b64_tr_b16 v[62:63], v3 offset:33280
    v_mfma_f32_16x16x32_bf16 v[168:171], v[64:67], v[48:51], v[168:171]
    v_mfma_f32_16x16x32_bf16 v[172:175], v[64:67], v[52:55], v[172:175]
    s_waitcnt lgkmcnt(4)
    v_mfma_f32_16x16x32_bf16 v[188:191], v[68:71], v[52:55], v[188:191]
    ds_read_b64_tr_b16 v[64:65], v6 offset:36864
    v_mfma_f32_16x16x32_bf16 v[184:187], v[68:71], v[48:51], v[184:187]
    ds_read_b64_tr_b16 v[66:67], v6 offset:37376
    v_mfma_f32_16x16x32_bf16 v[180:183], v[68:71], v[44:47], v[180:183]
    v_mfma_f32_16x16x32_bf16 v[176:179], v[68:71], v[40:43], v[176:179]
    s_waitcnt lgkmcnt(4)
    v_mfma_f32_16x16x32_bf16 v[192:195], v[56:59], v[40:43], v[192:195]
    ds_read_b64_tr_b16 v[68:69], v7 offset:36864
    v_mfma_f32_16x16x32_bf16 v[196:199], v[56:59], v[44:47], v[196:199]
    ds_read_b64_tr_b16 v[70:71], v7 offset:37376
    v_mfma_f32_16x16x32_bf16 v[200:203], v[56:59], v[48:51], v[200:203]
    v_mfma_f32_16x16x32_bf16 v[204:207], v[56:59], v[52:55], v[204:207]
    s_waitcnt lgkmcnt(0) vmcnt(8)
    s_barrier
    v_mfma_f32_16x16x32_bf16 v[220:223], v[60:63], v[52:55], v[220:223]
    ds_read_b64_tr_b16 v[56:57], v2 offset:40960
    ds_read_b64_tr_b16 v[58:59], v2 offset:41472
    v_mfma_f32_16x16x32_bf16 v[216:219], v[60:63], v[48:51], v[216:219]
    ds_read_b128 v[24:27], v1 offset:32768
    v_mfma_f32_16x16x32_bf16 v[212:215], v[60:63], v[44:47], v[212:215]
    ds_read_b128 v[28:31], v1 offset:33792
    v_mfma_f32_16x16x32_bf16 v[208:211], v[60:63], v[40:43], v[208:211]
    s_add_u32 m0, s44, 16384
    s_add_u32 s34, s34, s39
    buffer_load_dwordx4 v13, s[20:23], s34 offen sc1 lds
    v_mfma_f32_16x16x32_bf16 v[224:227], v[64:67], v[40:43], v[224:227]
    ds_read_b64_tr_b16 v[60:61], v3 offset:40960
    ds_read_b64_tr_b16 v[62:63], v3 offset:41472
    v_mfma_f32_16x16x32_bf16 v[228:231], v[64:67], v[44:47], v[228:231]
    ds_read_b128 v[32:35], v1 offset:34816
    v_mfma_f32_16x16x32_bf16 v[232:235], v[64:67], v[48:51], v[232:235]
    ds_read_b128 v[36:39], v1 offset:35840
    v_mfma_f32_16x16x32_bf16 v[236:239], v[64:67], v[52:55], v[236:239]
    s_add_u32 m0, s43, 16384
    s_add_u32 s42, s42, 8192
    buffer_load_dwordx4 v10, s[8:11], s42 offen sc1 lds
    v_mfma_f32_16x16x32_bf16 v[252:255], v[68:71], v[52:55], v[252:255]
    ds_read_b64_tr_b16 v[64:65], v2 offset:45056
    v_mfma_f32_16x16x32_bf16 v[248:251], v[68:71], v[48:51], v[248:251]
    ds_read_b64_tr_b16 v[66:67], v2 offset:45568
    v_mfma_f32_16x16x32_bf16 v[244:247], v[68:71], v[44:47], v[244:247]
    s_add_u32 m0, s44, 24576
    s_add_u32 s35, s35, s40
    buffer_load_dwordx4 v14, s[24:27], s35 offen sc1 lds
    v_mfma_f32_16x16x32_bf16 v[240:243], v[68:71], v[40:43], v[240:243]
    s_waitcnt lgkmcnt(2)
    v_mfma_f32_16x16x32_bf16 v[96:99], v[56:59], v[24:27], v[96:99]
    ds_read_b64_tr_b16 v[68:69], v3 offset:45056
    v_mfma_f32_16x16x32_bf16 v[100:103], v[56:59], v[28:31], v[100:103]
    ds_read_b64_tr_b16 v[70:71], v3 offset:45568
    v_mfma_f32_16x16x32_bf16 v[104:107], v[56:59], v[32:35], v[104:107]
    s_add_u32 m0, s43, 24576
    s_add_u32 s42, s42, 8192
    buffer_load_dwordx4 v10, s[8:11], s42 offen sc1 lds
    v_mfma_f32_16x16x32_bf16 v[108:111], v[56:59], v[36:39], v[108:111]
    v_mfma_f32_16x16x32_bf16 v[124:127], v[60:63], v[36:39], v[124:127]
    ds_read_b64_tr_b16 v[56:57], v2 offset:49152
    v_mfma_f32_16x16x32_bf16 v[120:123], v[60:63], v[32:35], v[120:123]
    ds_read_b64_tr_b16 v[58:59], v2 offset:49664
    v_mfma_f32_16x16x32_bf16 v[116:119], v[60:63], v[28:31], v[116:119]
    s_add_u32 m0, s44, 32768
    s_add_u32 s36, s36, s41
    buffer_load_dwordx4 v15, s[28:31], s36 offen sc1 lds
    v_mfma_f32_16x16x32_bf16 v[112:115], v[60:63], v[24:27], v[112:115]
    s_waitcnt lgkmcnt(4)
    v_mfma_f32_16x16x32_bf16 v[128:131], v[64:67], v[24:27], v[128:131]
    ds_read_b64_tr_b16 v[60:61], v3 offset:49152
    v_mfma_f32_16x16x32_bf16 v[132:135], v[64:67], v[28:31], v[132:135]
    ds_read_b64_tr_b16 v[62:63], v3 offset:49664
    v_mfma_f32_16x16x32_bf16 v[136:139], v[64:67], v[32:35], v[136:139]
    v_mfma_f32_16x16x32_bf16 v[140:143], v[64:67], v[36:39], v[140:143]
    s_waitcnt lgkmcnt(4)
    v_mfma_f32_16x16x32_bf16 v[156:159], v[68:71], v[36:39], v[156:159]
    ds_read_b64_tr_b16 v[64:65], v2 offset:53248
    v_mfma_f32_16x16x32_bf16 v[152:155], v[68:71], v[32:35], v[152:155]
    ds_read_b64_tr_b16 v[66:67], v2 offset:53760
    v_mfma_f32_16x16x32_bf16 v[148:151], v[68:71], v[28:31], v[148:151]
    v_mfma_f32_16x16x32_bf16 v[144:147], v[68:71], v[24:27], v[144:147]
    s_waitcnt lgkmcnt(4)
    v_mfma_f32_16x16x32_bf16 v[160:163], v[56:59], v[24:27], v[160:163]
    ds_read_b64_tr_b16 v[68:69], v3 offset:53248
    v_mfma_f32_16x16x32_bf16 v[164:167], v[56:59], v[28:31], v[164:167]
    ds_read_b64_tr_b16 v[70:71], v3 offset:53760
    v_mfma_f32_16x16x32_bf16 v[168:171], v[56:59], v[32:35], v[168:171]
    v_mfma_f32_16x16x32_bf16 v[172:175], v[56:59], v[36:39], v[172:175]
    s_waitcnt lgkmcnt(4)
    v_mfma_f32_16x16x32_bf16 v[188:191], v[60:63], v[36:39], v[188:191]
    ds_read_b64_tr_b16 v[56:57], v6 offset:57344
    v_mfma_f32_16x16x32_bf16 v[184:187], v[60:63], v[32:35], v[184:187]
    ds_read_b64_tr_b16 v[58:59], v6 offset:57856
    v_mfma_f32_16x16x32_bf16 v[180:183], v[60:63], v[28:31], v[180:183]
    v_mfma_f32_16x16x32_bf16 v[176:179], v[60:63], v[24:27], v[176:179]
    s_waitcnt lgkmcnt(4)
    v_mfma_f32_16x16x32_bf16 v[192:195], v[64:67], v[24:27], v[192:195]
    ds_read_b64_tr_b16 v[60:61], v7 offset:57344
    v_mfma_f32_16x16x32_bf16 v[196:199], v[64:67], v[28:31], v[196:199]
    ds_read_b64_tr_b16 v[62:63], v7 offset:57856
    v_mfma_f32_16x16x32_bf16 v[200:203], v[64:67], v[32:35], v[200:203]
    v_mfma_f32_16x16x32_bf16 v[204:207], v[64:67], v[36:39], v[204:207]
    s_waitcnt lgkmcnt(0) vmcnt(9)
    s_barrier
    v_mfma_f32_16x16x32_bf16 v[220:223], v[68:71], v[36:39], v[220:223]
    ds_read_b64_tr_b16 v[64:65], v4 offset:0
    ds_read_b64_tr_b16 v[66:67], v4 offset:512
    v_mfma_f32_16x16x32_bf16 v[216:219], v[68:71], v[32:35], v[216:219]
    ds_read_b128 v[40:43], v1 offset:49152
    v_mfma_f32_16x16x32_bf16 v[212:215], v[68:71], v[28:31], v[212:215]
    ds_read_b128 v[44:47], v1 offset:50176
    v_mfma_f32_16x16x32_bf16 v[208:211], v[68:71], v[24:27], v[208:211]
    s_add_u32 m0, s43, 32768
    s_add_u32 s42, s42, 8192
    buffer_load_dwordx4 v10, s[8:11], s42 offen sc1 lds
    v_mfma_f32_16x16x32_bf16 v[224:227], v[56:59], v[24:27], v[224:227]
    ds_read_b64_tr_b16 v[68:69], v5 offset:0
    ds_read_b64_tr_b16 v[70:71], v5 offset:512
    v_mfma_f32_16x16x32_bf16 v[228:231], v[56:59], v[28:31], v[228:231]
    ds_read_b128 v[48:51], v1 offset:51200
    v_mfma_f32_16x16x32_bf16 v[232:235], v[56:59], v[32:35], v[232:235]
    ds_read_b128 v[52:55], v1 offset:52224
    v_mfma_f32_16x16x32_bf16 v[236:239], v[56:59], v[36:39], v[236:239]
    s_add_u32 m0, s44, 40960
    s_add_u32 s32, s32, s37
    buffer_load_dwordx4 v11, s[12:15], s32 offen sc1 lds
    v_mfma_f32_16x16x32_bf16 v[252:255], v[60:63], v[36:39], v[252:255]
    ds_read_b64_tr_b16 v[56:57], v4 offset:4096
    v_mfma_f32_16x16x32_bf16 v[248:251], v[60:63], v[32:35], v[248:251]
    ds_read_b64_tr_b16 v[58:59], v4 offset:4608
    v_mfma_f32_16x16x32_bf16 v[244:247], v[60:63], v[28:31], v[244:247]
    s_add_u32 m0, s43, 40960
    s_add_u32 s42, s42, 8192
    buffer_load_dwordx4 v10, s[8:11], s42 offen sc1 lds
    v_mfma_f32_16x16x32_bf16 v[240:243], v[60:63], v[24:27], v[240:243]
    s_waitcnt lgkmcnt(2)
    v_mfma_f32_16x16x32_bf16 v[96:99], v[64:67], v[40:43], v[96:99]
    ds_read_b64_tr_b16 v[60:61], v5 offset:4096
    v_mfma_f32_16x16x32_bf16 v[100:103], v[64:67], v[44:47], v[100:103]
    ds_read_b64_tr_b16 v[62:63], v5 offset:4608
    v_mfma_f32_16x16x32_bf16 v[104:107], v[64:67], v[48:51], v[104:107]
    s_add_u32 m0, s44, 49152
    s_add_u32 s33, s33, s38
    buffer_load_dwordx4 v12, s[16:19], s33 offen sc1 lds
    v_mfma_f32_16x16x32_bf16 v[108:111], v[64:67], v[52:55], v[108:111]
    v_mfma_f32_16x16x32_bf16 v[124:127], v[68:71], v[52:55], v[124:127]
    ds_read_b64_tr_b16 v[64:65], v4 offset:8192
    v_mfma_f32_16x16x32_bf16 v[120:123], v[68:71], v[48:51], v[120:123]
    ds_read_b64_tr_b16 v[66:67], v4 offset:8704
    v_mfma_f32_16x16x32_bf16 v[116:119], v[68:71], v[44:47], v[116:119]
    v_mfma_f32_16x16x32_bf16 v[112:115], v[68:71], v[40:43], v[112:115]
    s_waitcnt lgkmcnt(4)
    v_mfma_f32_16x16x32_bf16 v[128:131], v[56:59], v[40:43], v[128:131]
    ds_read_b64_tr_b16 v[68:69], v5 offset:8192
    v_mfma_f32_16x16x32_bf16 v[132:135], v[56:59], v[44:47], v[132:135]
    ds_read_b64_tr_b16 v[70:71], v5 offset:8704
    v_mfma_f32_16x16x32_bf16 v[136:139], v[56:59], v[48:51], v[136:139]
    v_mfma_f32_16x16x32_bf16 v[140:143], v[56:59], v[52:55], v[140:143]
    s_waitcnt lgkmcnt(4)
    v_mfma_f32_16x16x32_bf16 v[156:159], v[60:63], v[52:55], v[156:159]
    ds_read_b64_tr_b16 v[56:57], v4 offset:12288
    v_mfma_f32_16x16x32_bf16 v[152:155], v[60:63], v[48:51], v[152:155]
    ds_read_b64_tr_b16 v[58:59], v4 offset:12800
    v_mfma_f32_16x16x32_bf16 v[148:151], v[60:63], v[44:47], v[148:151]
    v_mfma_f32_16x16x32_bf16 v[144:147], v[60:63], v[40:43], v[144:147]
    s_waitcnt lgkmcnt(4)
    v_mfma_f32_16x16x32_bf16 v[160:163], v[64:67], v[40:43], v[160:163]
    ds_read_b64_tr_b16 v[60:61], v5 offset:12288
    v_mfma_f32_16x16x32_bf16 v[164:167], v[64:67], v[44:47], v[164:167]
    ds_read_b64_tr_b16 v[62:63], v5 offset:12800
    v_mfma_f32_16x16x32_bf16 v[168:171], v[64:67], v[48:51], v[168:171]
    v_mfma_f32_16x16x32_bf16 v[172:175], v[64:67], v[52:55], v[172:175]
    s_waitcnt lgkmcnt(4)
    v_mfma_f32_16x16x32_bf16 v[188:191], v[68:71], v[52:55], v[188:191]
    ds_read_b64_tr_b16 v[64:65], v8 offset:16384
    v_mfma_f32_16x16x32_bf16 v[184:187], v[68:71], v[48:51], v[184:187]
    ds_read_b64_tr_b16 v[66:67], v8 offset:16896
    v_mfma_f32_16x16x32_bf16 v[180:183], v[68:71], v[44:47], v[180:183]
    v_mfma_f32_16x16x32_bf16 v[176:179], v[68:71], v[40:43], v[176:179]
    s_waitcnt lgkmcnt(4)
    v_mfma_f32_16x16x32_bf16 v[192:195], v[56:59], v[40:43], v[192:195]
    ds_read_b64_tr_b16 v[68:69], v9 offset:16384
    v_mfma_f32_16x16x32_bf16 v[196:199], v[56:59], v[44:47], v[196:199]
    ds_read_b64_tr_b16 v[70:71], v9 offset:16896
    v_mfma_f32_16x16x32_bf16 v[200:203], v[56:59], v[48:51], v[200:203]
    v_mfma_f32_16x16x32_bf16 v[204:207], v[56:59], v[52:55], v[204:207]
    s_waitcnt lgkmcnt(0) vmcnt(8)
    s_barrier
    v_mfma_f32_16x16x32_bf16 v[220:223], v[60:63], v[52:55], v[220:223]
    ds_read_b64_tr_b16 v[56:57], v2 offset:0
    ds_read_b64_tr_b16 v[58:59], v2 offset:512
    v_mfma_f32_16x16x32_bf16 v[216:219], v[60:63], v[48:51], v[216:219]
    ds_read_b128 v[24:27], v1 offset:0
    v_mfma_f32_16x16x32_bf16 v[212:215], v[60:63], v[44:47], v[212:215]
    ds_read_b128 v[28:31], v1 offset:1024
    v_mfma_f32_16x16x32_bf16 v[208:211], v[60:63], v[40:43], v[208:211]
    s_add_u32 m0, s44, 57344
    s_add_u32 s34, s34, s39
    buffer_load_dwordx4 v13, s[20:23], s34 offen sc1 lds
    v_mfma_f32_16x16x32_bf16 v[224:227], v[64:67], v[40:43], v[224:227]
    ds_read_b64_tr_b16 v[60:61], v3 offset:0
    ds_read_b64_tr_b16 v[62:63], v3 offset:512
    v_mfma_f32_16x16x32_bf16 v[228:231], v[64:67], v[44:47], v[228:231]
    ds_read_b128 v[32:35], v1 offset:2048
    v_mfma_f32_16x16x32_bf16 v[232:235], v[64:67], v[48:51], v[232:235]
    ds_read_b128 v[36:39], v1 offset:3072
    v_mfma_f32_16x16x32_bf16 v[236:239], v[64:67], v[52:55], v[236:239]
    s_add_u32 m0, s43, 49152
    s_add_u32 s42, s42, 8192
    buffer_load_dwordx4 v10, s[8:11], s42 offen sc1 lds
    v_mfma_f32_16x16x32_bf16 v[252:255], v[68:71], v[52:55], v[252:255]
    ds_read_b64_tr_b16 v[64:65], v2 offset:4096
    v_mfma_f32_16x16x32_bf16 v[248:251], v[68:71], v[48:51], v[248:251]
    ds_read_b64_tr_b16 v[66:67], v2 offset:4608
    v_mfma_f32_16x16x32_bf16 v[244:247], v[68:71], v[44:47], v[244:247]
    s_add_u32 m0, s44, 65536
    s_add_u32 s35, s35, s40
    buffer_load_dwordx4 v14, s[24:27], s35 offen sc1 lds
    v_mfma_f32_16x16x32_bf16 v[240:243], v[68:71], v[40:43], v[240:243]
    s_sub_u32 s60, s60, 1
    s_cmp_lg_u32 s60, 0
    s_cbranch_scc1 G1_loop
    s_waitcnt lgkmcnt(2)
    v_mfma_f32_16x16x32_bf16 v[96:99], v[56:59], v[24:27], v[96:99]
    ds_read_b64_tr_b16 v[68:69], v3 offset:4096
    v_mfma_f32_16x16x32_bf16 v[100:103], v[56:59], v[28:31], v[100:103]
    ds_read_b64_tr_b16 v[70:71], v3 offset:4608
    v_mfma_f32_16x16x32_bf16 v[104:107], v[56:59], v[32:35], v[104:107]
    s_add_u32 m0, s43, 57344
    s_add_u32 s42, s42, 8192
    buffer_load_dwordx4 v10, s[8:11], s42 offen sc1 lds
    v_mfma_f32_16x16x32_bf16 v[108:111], v[56:59], v[36:39], v[108:111]
    v_mfma_f32_16x16x32_bf16 v[124:127], v[60:63], v[36:39], v[124:127]
    ds_read_b64_tr_b16 v[56:57], v2 offset:8192
    v_mfma_f32_16x16x32_bf16 v[120:123], v[60:63], v[32:35], v[120:123]
    ds_read_b64_tr_b16 v[58:59], v2 offset:8704
    v_mfma_f32_16x16x32_bf16 v[116:119], v[60:63], v[28:31], v[116:119]
    s_add_u32 m0, s44, 73728
    s_add_u32 s36, s36, s41
    buffer_load_dwordx4 v15, s[28:31], s36 offen sc1 lds
    v_mfma_f32_16x16x32_bf16 v[112:115], v[60:63], v[24:27], v[112:115]
    s_waitcnt lgkmcnt(4)
    v_mfma_f32_16x16x32_bf16 v[128:131], v[64:67], v[24:27], v[128:131]
    ds_read_b64_tr_b16 v[60:61], v3 offset:8192
    v_mfma_f32_16x16x32_bf16 v[132:135], v[64:67], v[28:31], v[132:135]
    ds_read_b64_tr_b16 v[62:63], v3 offset:8704
    v_mfma_f32_16x16x32_bf16 v[136:139], v[64:67], v[32:35], v[136:139]
    v_mfma_f32_16x16x32_bf16 v[140:143], v[64:67], v[36:39], v[140:143]
    s_waitcnt lgkmcnt(4)
    v_mfma_f32_16x16x32_bf16 v[156:159], v[68:71], v[36:39], v[156:159]
    ds_read_b64_tr_b16 v[64:65], v2 offset:12288
    v_mfma_f32_16x16x32_bf16 v[152:155], v[68:71], v[32:35], v[152:155]
    ds_read_b64_tr_b16 v[66:67], v2 offset:12800
    v_mfma_f32_16x16x32_bf16 v[148:151], v[68:71], v[28:31], v[148:151]
    v_mfma_f32_16x16x32_bf16 v[144:147], v[68:71], v[24:27], v[144:147]
    s_waitcnt lgkmcnt(4)
    v_mfma_f32_16x16x32_bf16 v[160:163], v[56:59], v[24:27], v[160:163]
    ds_read_b64_tr_b16 v[68:69], v3 offset:12288
    v_mfma_f32_16x16x32_bf16 v[164:167], v[56:59], v[28:31], v[164:167]
    ds_read_b64_tr_b16 v[70:71], v3 offset:12800
    v_mfma_f32_16x16x32_bf16 v[168:171], v[56:59], v[32:35], v[168:171]
    v_mfma_f32_16x16x32_bf16 v[172:175], v[56:59], v[36:39], v[172:175]
    s_waitcnt lgkmcnt(4)
    v_mfma_f32_16x16x32_bf16 v[188:191], v[60:63], v[36:39], v[188:191]
    ds_read_b64_tr_b16 v[56:57], v6 offset:16384
    v_mfma_f32_16x16x32_bf16 v[184:187], v[60:63], v[32:35], v[184:187]
    ds_read_b64_tr_b16 v[58:59], v6 offset:16896
    v_mfma_f32_16x16x32_bf16 v[180:183], v[60:63], v[28:31], v[180:183]
    v_mfma_f32_16x16x32_bf16 v[176:179], v[60:63], v[24:27], v[176:179]
    s_waitcnt lgkmcnt(4)
    v_mfma_f32_16x16x32_bf16 v[192:195], v[64:67], v[24:27], v[192:195]
    ds_read_b64_tr_b16 v[60:61], v7 offset:16384
    v_mfma_f32_16x16x32_bf16 v[196:199], v[64:67], v[28:31], v[196:199]
    ds_read_b64_tr_b16 v[62:63], v7 offset:16896
    v_mfma_f32_16x16x32_bf16 v[200:203], v[64:67], v[32:35], v[200:203]
    v_mfma_f32_16x16x32_bf16 v[204:207], v[64:67], v[36:39], v[204:207]
    s_waitcnt lgkmcnt(0) vmcnt(9)
    s_barrier
    v_mfma_f32_16x16x32_bf16 v[220:223], v[68:71], v[36:39], v[220:223]
    ds_read_b64_tr_b16 v[64:65], v2 offset:20480
    v_mfma_f32_16x16x32_bf16 v[216:219], v[68:71], v[32:35], v[216:219]
    ds_read_b64_tr_b16 v[66:67], v2 offset:20992
    v_mfma_f32_16x16x32_bf16 v[212:215], v[68:71], v[28:31], v[212:215]
    ds_read_b128 v[40:43], v1 offset:16384
    v_mfma_f32_16x16x32_bf16 v[208:211], v[68:71], v[24:27], v[208:211]
    ds_read_b128 v[44:47], v1 offset:17408
    v_mfma_f32_16x16x32_bf16 v[224:227], v[56:59], v[24:27], v[224:227]
    ds_read_b64_tr_b16 v[68:69], v3 offset:20480
    v_mfma_f32_16x16x32_bf16 v[228:231], v[56:59], v[28:31], v[228:231]
    ds_read_b64_tr_b16 v[70:71], v3 offset:20992
    v_mfma_f32_16x16x32_bf16 v[232:235], v[56:59], v[32:35], v[232:235]
    ds_read_b128 v[48:51], v1 offset:18432
    v_mfma_f32_16x16x32_bf16 v[236:239], v[56:59], v[36:39], v[236:239]
    ds_read_b128 v[52:55], v1 offset:19456
    v_mfma_f32_16x16x32_bf16 v[252:255], v[60:63], v[36:39], v[252:255]
    ds_read_b64_tr_b16 v[56:57], v2 offset:24576
    v_mfma_f32_16x16x32_bf16 v[248:251], v[60:63], v[32:35], v[248:251]
    ds_read_b64_tr_b16 v[58:59], v2 offset:25088
    v_mfma_f32_16x16x32_bf16 v[244:247], v[60:63], v[28:31], v[244:247]
    v_mfma_f32_16x16x32_bf16 v[240:243], v[60:63], v[24:27], v[240:243]
    s_waitcnt lgkmcnt(2)
    v_mfma_f32_16x16x32_bf16 v[96:99], v[64:67], v[40:43], v[96:99]
    ds_read_b64_tr_b16 v[60:61], v3 offset:24576
    v_mfma_f32_16x16x32_bf16 v[100:103], v[64:67], v[44:47], v[100:103]
    ds_read_b64_tr_b16 v[62:63], v3 offset:25088
    v_mfma_f32_16x16x32_bf16 v[104:107], v[64:67], v[48:51], v[104:107]
    v_mfma_f32_16x16x32_bf16 v[108:111], v[64:67], v[52:55], v[108:111]
    v_mfma_f32_16x16x32_bf16 v[124:127], v[68:71], v[52:55], v[124:127]
    ds_read_b64_tr_b16 v[64:65], v2 offset:28672
    v_mfma_f32_16x16x32_bf16 v[120:123], v[68:71], v[48:51], v[120:123]
    ds_read_b64_tr_b16 v[66:67], v2 offset:29184
    v_mfma_f32_16x16x32_bf16 v[116:119], v[68:71], v[44:47], v[116:119]
    v_mfma_f32_16x16x32_bf16 v[112:115], v[68:71], v[40:43], v[112:115]
    s_waitcnt lgkmcnt(4)
    v_mfma_f32_16x16x32_bf16 v[128:131], v[56:59], v[40:43], v[128:131]
    ds_read_b64_tr_b16 v[68:69], v3 offset:28672
    v_mfma_f32_16x16x32_bf16 v[132:135], v[56:59], v[44:47], v[132:135]
    ds_read_b64_tr_b16 v[70:71], v3 offset:29184
    v_mfma_f32_16x16x32_bf16 v[136:139], v[56:59], v[48:51], v[136:139]
    v_mfma_f32_16x16x32_bf16 v[140:143], v[56:59], v[52:55], v[140:143]
    s_waitcnt lgkmcnt(4)
    v_mfma_f32_16x16x32_bf16 v[156:159], v[60:63], v[52:55], v[156:159]
    ds_read_b64_tr_b16 v[56:57], v2 offset:32768
    v_mfma_f32_16x16x32_bf16 v[152:155], v[60:63], v[48:51], v[152:155]
    ds_read_b64_tr_b16 v[58:59], v2 offset:33280
    v_mfma_f32_16x16x32_bf16 v[148:151], v[60:63], v[44:47], v[148:151]
    v_mfma_f32_16x16x32_bf16 v[144:147], v[60:63], v[40:43], v[144:147]
    s_waitcnt lgkmcnt(4)
    v_mfma_f32_16x16x32_bf16 v[160:163], v[64:67], v[40:43], v[160:163]
    ds_read_b64_tr_b16 v[60:61], v3 offset:32768
    v_mfma_f32_16x16x32_bf16 v[164:167], v[64:67], v[44:47], v[164:167]
    ds_read_b64_tr_b16 v[62:63], v3 offset:33280
    v_mfma_f32_16x16x32_bf16 v[168:171], v[64:67], v[48:51], v[168:171]
    v_mfma_f32_16x16x32_bf16 v[172:175], v[64:67], v[52:55], v[172:175]
    s_waitcnt lgkmcnt(4)
    v_mfma_f32_16x16x32_bf16 v[188:191], v[68:71], v[52:55], v[188:191]
    ds_read_b64_tr_b16 v[64:65], v6 offset:36864
    v_mfma_f32_16x16x32_bf16 v[184:187], v[68:71], v[48:51], v[184:187]
    ds_read_b64_tr_b16 v[66:67], v6 offset:37376
    v_mfma_f32_16x16x32_bf16 v[180:183], v[68:71], v[44:47], v[180:183]
    v_mfma_f32_16x16x32_bf16 v[176:179], v[68:71], v[40:43], v[176:179]
    s_waitcnt lgkmcnt(4)
    v_mfma_f32_16x16x32_bf16 v[192:195], v[56:59], v[40:43], v[192:195]
    ds_read_b64_tr_b16 v[68:69], v7 offset:36864
    v_mfma_f32_16x16x32_bf16 v[196:199], v[56:59], v[44:47], v[196:199]
    ds_read_b64_tr_b16 v[70:71], v7 offset:37376
    v_mfma_f32_16x16x32_bf16 v[200:203], v[56:59], v[48:51], v[200:203]
    v_mfma_f32_16x16x32_bf16 v[204:207], v[56:59], v[52:55], v[204:207]
    s_waitcnt lgkmcnt(0) vmcnt(4)
    s_barrier
    v_mfma_f32_16x16x32_bf16 v[220:223], v[60:63], v[52:55], v[220:223]
    ds_read_b64_tr_b16 v[56:57], v2 offset:40960
    v_mfma_f32_16x16x32_bf16 v[216:219], v[60:63], v[48:51], v[216:219]
    ds_read_b64_tr_b16 v[58:59], v2 offset:41472
    v_mfma_f32_16x16x32_bf16 v[212:215], v[60:63], v[44:47], v[212:215]
    ds_read_b128 v[24:27], v1 offset:32768
    v_mfma_f32_16x16x32_bf16 v[208:211], v[60:63], v[40:43], v[208:211]
    ds_read_b128 v[28:31], v1 offset:33792
    v_mfma_f32_16x16x32_bf16 v[224:227], v[64:67], v[40:43], v[224:227]
    ds_read_b64_tr_b16 v[60:61], v3 offset:40960
    v_mfma_f32_16x16x32_bf16 v[228:231], v[64:67], v[44:47], v[228:231]
    ds_read_b64_tr_b16 v[62:63], v3 offset:41472
    v_mfma_f32_16x16x32_bf16 v[232:235], v[64:67], v[48:51], v[232:235]
    ds_read_b128 v[32:35], v1 offset:34816
    v_mfma_f32_16x16x32_bf16 v[236:239], v[64:67], v[52:55], v[236:239]
    ds_read_b128 v[36:39], v1 offset:35840
    v_mfma_f32_16x16x32_bf16 v[252:255], v[68:71], v[52:55], v[252:255]
    ds_read_b64_tr_b16 v[64:65], v2 offset:45056
    v_mfma_f32_16x16x32_bf16 v[248:251], v[68:71], v[48:51], v[248:251]
    ds_read_b64_tr_b16 v[66:67], v2 offset:45568
    v_mfma_f32_16x16x32_bf16 v[244:247], v[68:71], v[44:47], v[244:247]
    v_mfma_f32_16x16x32_bf16 v[240:243], v[68:71], v[40:43], v[240:243]
    s_waitcnt lgkmcnt(2)
    v_mfma_f32_16x16x32_bf16 v[96:99], v[56:59], v[24:27], v[96:99]
    ds_read_b64_tr_b16 v[68:69], v3 offset:45056
    v_mfma_f32_16x16x32_bf16 v[100:103], v[56:59], v[28:31], v[100:103]
    ds_read_b64_tr_b16 v[70:71], v3 offset:45568
    v_mfma_f32_16x16x32_bf16 v[104:107], v[56:59], v[32:35], v[104:107]
    v_mfma_f32_16x16x32_bf16 v[108:111], v[56:59], v[36:39], v[108:111]
    v_mfma_f32_16x16x32_bf16 v[124:127], v[60:63], v[36:39], v[124:127]
    ds_read_b64_tr_b16 v[56:57], v2 offset:49152
    v_mfma_f32_16x16x32_bf16 v[120:123], v[60:63], v[32:35], v[120:123]
    ds_read_b64_tr_b16 v[58:59], v2 offset:49664
    v_mfma_f32_16x16x32_bf16 v[116:119], v[60:63], v[28:31], v[116:119]
    v_mfma_f32_16x16x32_bf16 v[112:115], v[60:63], v[24:27], v[112:115]
    s_waitcnt lgkmcnt(4)
    v_mfma_f32_16x16x32_bf16 v[128:131], v[64:67], v[24:27], v[128:131]
    ds_read_b64_tr_b16 v[60:61], v3 offset:49152
    v_mfma_f32_16x16x32_bf16 v[132:135], v[64:67], v[28:31], v[132:135]
    ds_read_b64_tr_b16 v[62:63], v3 offset:49664
    v_mfma_f32_16x16x32_bf16 v[136:139], v[64:67], v[32:35], v[136:139]
    v_mfma_f32_16x16x32_bf16 v[140:143], v[64:67], v[36:39], v[140:143]
    s_waitcnt lgkmcnt(4)
    v_mfma_f32_16x16x32_bf16 v[156:159], v[68:71], v[36:39], v[156:159]
    ds_read_b64_tr_b16 v[64:65], v2 offset:53248
    v_mfma_f32_16x16x32_bf16 v[152:155], v[68:71], v[32:35], v[152:155]
    ds_read_b64_tr_b16 v[66:67], v2 offset:53760
    v_mfma_f32_16x16x32_bf16 v[148:151], v[68:71], v[28:31], v[148:151]
    v_mfma_f32_16x16x32_bf16 v[144:147], v[68:71], v[24:27], v[144:147]
    s_waitcnt lgkmcnt(4)
    v_mfma_f32_16x16x32_bf16 v[160:163], v[56:59], v[24:27], v[160:163]
    ds_read_b64_tr_b16 v[68:69], v3 offset:53248
    v_mfma_f32_16x16x32_bf16 v[164:167], v[56:59], v[28:31], v[164:167]
    ds_read_b64_tr_b16 v[70:71], v3 offset:53760
    v_mfma_f32_16x16x32_bf16 v[168:171], v[56:59], v[32:35], v[168:171]
    v_mfma_f32_16x16x32_bf16 v[172:175], v[56:59], v[36:39], v[172:175]
    s_waitcnt lgkmcnt(4)
    v_mfma_f32_16x16x32_bf16 v[188:191], v[60:63], v[36:39], v[188:191]
    ds_read_b64_tr_b16 v[56:57], v6 offset:57344
    v_mfma_f32_16x16x32_bf16 v[184:187], v[60:63], v[32:35], v[184:187]
    ds_read_b64_tr_b16 v[58:59], v6 offset:57856
    v_mfma_f32_16x16x32_bf16 v[180:183], v[60:63], v[28:31], v[180:183]
    v_mfma_f32_16x16x32_bf16 v[176:179], v[60:63], v[24:27], v[176:179]
    s_waitcnt lgkmcnt(4)
    v_mfma_f32_16x16x32_bf16 v[192:195], v[64:67], v[24:27], v[192:195]
    ds_read_b64_tr_b16 v[60:61], v7 offset:57344
    v_mfma_f32_16x16x32_bf16 v[196:199], v[64:67], v[28:31], v[196:199]
    ds_read_b64_tr_b16 v[62:63], v7 offset:57856
    v_mfma_f32_16x16x32_bf16 v[200:203], v[64:67], v[32:35], v[200:203]
    v_mfma_f32_16x16x32_bf16 v[204:207], v[64:67], v[36:39], v[204:207]
    s_waitcnt lgkmcnt(0) vmcnt(0)
    s_barrier
    v_mfma_f32_16x16x32_bf16 v[220:223], v[68:71], v[36:39], v[220:223]
    ds_read_b64_tr_b16 v[64:65], v4 offset:0
    v_mfma_f32_16x16x32_bf16 v[216:219], v[68:71], v[32:35], v[216:219]
    ds_read_b64_tr_b16 v[66:67], v4 offset:512
    v_mfma_f32_16x16x32_bf16 v[212:215], v[68:71], v[28:31], v[212:215]
    ds_read_b128 v[40:43], v1 offset:49152
    v_mfma_f32_16x16x32_bf16 v[208:211], v[68:71], v[24:27], v[208:211]
    ds_read_b128 v[44:47], v1 offset:50176
    v_mfma_f32_16x16x32_bf16 v[224:227], v[56:59], v[24:27], v[224:227]
    ds_read_b64_tr_b16 v[68:69], v5 offset:0
    v_mfma_f32_16x16x32_bf16 v[228:231], v[56:59], v[28:31], v[228:231]
    ds_read_b64_tr_b16 v[70:71], v5 offset:512
    v_mfma_f32_16x16x32_bf16 v[232:235], v[56:59], v[32:35], v[232:235]
    ds_read_b128 v[48:51], v1 offset:51200
    v_mfma_f32_16x16x32_bf16 v[236:239], v[56:59], v[36:39], v[236:239]
    ds_read_b128 v[52:55], v1 offset:52224
    v_mfma_f32_16x16x32_bf16 v[252:255], v[60:63], v[36:39], v[252:255]
    ds_read_b64_tr_b16 v[56:57], v4 offset:4096
    v_mfma_f32_16x16x32_bf16 v[248:251], v[60:63], v[32:35], v[248:251]
    ds_read_b64_tr_b16 v[58:59], v4 offset:4608
    v_mfma_f32_16x16x32_bf16 v[244:247], v[60:63], v[28:31], v[244:247]
    v_mfma_f32_16x16x32_bf16 v[240:243], v[60:63], v[24:27], v[240:243]
    s_waitcnt lgkmcnt(2)
    v_mfma_f32_16x16x32_bf16 v[96:99], v[64:67], v[40:43], v[96:99]
    ds_read_b64_tr_b16 v[60:61], v5 offset:4096
    v_mfma_f32_16x16x32_bf16 v[100:103], v[64:67], v[44:47], v[100:103]
    ds_read_b64_tr_b16 v[62:63], v5 offset:4608
    v_mfma_f32_16x16x32_bf16 v[104:107], v[64:67], v[48:51], v[104:107]
    v_mfma_f32_16x16x32_bf16 v[108:111], v[64:67], v[52:55], v[108:111]
    v_mfma_f32_16x16x32_bf16 v[124:127], v[68:71], v[52:55], v[124:127]
    ds_read_b64_tr_b16 v[64:65], v4 offset:8192
    v_mfma_f32_16x16x32_bf16 v[120:123], v[68:71], v[48:51], v[120:123]
    ds_read_b64_tr_b16 v[66:67], v4 offset:8704
    v_mfma_f32_16x16x32_bf16 v[116:119], v[68:71], v[44:47], v[116:119]
    v_mfma_f32_16x16x32_bf16 v[112:115], v[68:71], v[40:43], v[112:115]
    s_waitcnt lgkmcnt(4)
    v_mfma_f32_16x16x32_bf16 v[128:131], v[56:59], v[40:43], v[128:131]
    ds_read_b64_tr_b16 v[68:69], v5 offset:8192
    v_mfma_f32_16x16x32_bf16 v[132:135], v[56:59], v[44:47], v[132:135]
    ds_read_b64_tr_b16 v[70:71], v5 offset:8704
    v_mfma_f32_16x16x32_bf16 v[136:139], v[56:59], v[48:51], v[136:139]
    v_mfma_f32_16x16x32_bf16 v[140:143], v[56:59], v[52:55], v[140:143]
    s_waitcnt lgkmcnt(4)
    v_mfma_f32_16x16x32_bf16 v[156:159], v[60:63], v[52:55], v[156:159]
    ds_read_b64_tr_b16 v[56:57], v4 offset:12288
    v_mfma_f32_16x16x32_bf16 v[152:155], v[60:63], v[48:51], v[152:155]
    ds_read_b64_tr_b16 v[58:59], v4 offset:12800
    v_mfma_f32_16x16x32_bf16 v[148:151], v[60:63], v[44:47], v[148:151]
    v_mfma_f32_16x16x32_bf16 v[144:147], v[60:63], v[40:43], v[144:147]
    s_waitcnt lgkmcnt(4)
    v_mfma_f32_16x16x32_bf16 v[160:163], v[64:67], v[40:43], v[160:163]
    ds_read_b64_tr_b16 v[60:61], v5 offset:12288
    v_mfma_f32_16x16x32_bf16 v[164:167], v[64:67], v[44:47], v[164:167]
    ds_read_b64_tr_b16 v[62:63], v5 offset:12800
    v_mfma_f32_16x16x32_bf16 v[168:171], v[64:67], v[48:51], v[168:171]
    v_mfma_f32_16x16x32_bf16 v[172:175], v[64:67], v[52:55], v[172:175]
    s_waitcnt lgkmcnt(4)
    v_mfma_f32_16x16x32_bf16 v[188:191], v[68:71], v[52:55], v[188:191]
    ds_read_b64_tr_b16 v[64:65], v8 offset:16384
    v_mfma_f32_16x16x32_bf16 v[184:187], v[68:71], v[48:51], v[184:187]
    ds_read_b64_tr_b16 v[66:67], v8 offset:16896
    v_mfma_f32_16x16x32_bf16 v[180:183], v[68:71], v[44:47], v[180:183]
    v_mfma_f32_16x16x32_bf16 v[176:179], v[68:71], v[40:43], v[176:179]
    s_waitcnt lgkmcnt(4)
    v_mfma_f32_16x16x32_bf16 v[192:195], v[56:59], v[40:43], v[192:195]
    ds_read_b64_tr_b16 v[68:69], v9 offset:16384
    v_mfma_f32_16x16x32_bf16 v[196:199], v[56:59], v[44:47], v[196:199]
    ds_read_b64_tr_b16 v[70:71], v9 offset:16896
    v_mfma_f32_16x16x32_bf16 v[200:203], v[56:59], v[48:51], v[200:203]
    v_mfma_f32_16x16x32_bf16 v[204:207], v[56:59], v[52:55], v[204:207]
    s_waitcnt lgkmcnt(4)
    v_mfma_f32_16x16x32_bf16 v[220:223], v[60:63], v[52:55], v[220:223]
    v_mfma_f32_16x16x32_bf16 v[216:219], v[60:63], v[48:51], v[216:219]
    v_mfma_f32_16x16x32_bf16 v[212:215], v[60:63], v[44:47], v[212:215]
    v_mfma_f32_16x16x32_bf16 v[208:211], v[60:63], v[40:43], v[208:211]
    s_waitcnt lgkmcnt(2)
    v_mfma_f32_16x16x32_bf16 v[224:227], v[64:67], v[40:43], v[224:227]
    v_mfma_f32_16x16x32_bf16 v[228:231], v[64:67], v[44:47], v[228:231]
    v_mfma_f32_16x16x32_bf16 v[232:235], v[64:67], v[48:51], v[232:235]
    v_mfma_f32_16x16x32_bf16 v[236:239], v[64:67], v[52:55], v[236:239]
    s_waitcnt lgkmcnt(0)
    v_mfma_f32_16x16x32_bf16 v[252:255], v[68:71], v[52:55], v[252:255]
    v_mfma_f32_16x16x32_bf16 v[248:251], v[68:71], v[48:51], v[248:251]
    v_mfma_f32_16x16x32_bf16 v[244:247], v[68:71], v[44:47], v[244:247]
    v_mfma_f32_16x16x32_bf16 v[240:243], v[68:71], v[40:43], v[240:243]
    s_waitcnt vmcnt(0) lgkmcnt(0)
    v_and_b32 v15, 63, v0
    v_lshlrev_b32 v1, 4, v15
    v_mov_b32 v14, v75
    v_lshl_or_b32 v16, v81, 16, v80
    v_lshl_or_b32 v17, v83, 16, v82
    v_lshl_or_b32 v18, v85, 16, v84
    v_lshl_or_b32 v19, v87, 16, v86
    v_lshl_or_b32 v20, v89, 16, v88
    v_lshl_or_b32 v21, v91, 16, v90
    v_lshl_or_b32 v22, v93, 16, v92
    v_lshl_or_b32 v23, v95, 16, v94
    s_mov_b32 s32, 0x3fb8aa3b
    s_mov_b32 s33, 0x3fb8aa3b
    s_mov_b32 s34, 0xbfb8aa3b
    s_mov_b32 s35, 0xbfb8aa3b
    s_mov_b32 s36, 1.0
    s_mov_b32 s37, 1.0
    s_lshl_b32 s54, s47, 1
    s_lshr_b32 s55, s52, 1
    s_add_u32 s54, s54, s55
    s_mul_i32 s54, s54, 1179648
    s_and_b32 s55, s52, 1
    s_lshl_b32 s55, s55, 12
    s_add_u32 s54, s54, s55
    s_add_u32 s54, s54, 8388608
    s_lshl_b32 s55, s51, 2
    s_lshl_b32 s56, s51, 1
    s_add_u32 s56, s56, 64
    s_cmp_eq_u32 s50, 0
    s_cselect_b32 s55, s55, s56
    s_add_u32 s55, s55, s53
    s_lshl_b32 s55, s55, 13
    s_add_u32 s55, s55, s54
    s_lshl_b32 s57, s51, 1
    s_add_u32 s57, s57, s53
    s_cmp_eq_u32 s50, 1
    s_cbranch_scc1 G1_T2
    s_lshl_b32 s58, s57, 17
    s_lshl_b32 s59, s47, 14
    s_add_u32 s58, s58, s59
    s_lshl_b32 s59, s52, 12
    s_add_u32 s58, s58, s59
    s_add_u32 s58, s58, 33554432
    v_cvt_pk_bf16_f32 v24, v224, v225
    v_cvt_pk_bf16_f32 v36, v228, v229
    v_cvt_pk_bf16_f32 v48, v232, v233
    v_cvt_pk_bf16_f32 v60, v236, v237
    v_cvt_pk_bf16_f32 v25, v226, v227
    v_cvt_pk_bf16_f32 v37, v230, v231
    v_cvt_pk_bf16_f32 v49, v234, v235
    v_cvt_pk_bf16_f32 v61, v238, v239
    v_cvt_pk_bf16_f32 v26, v240, v241
    v_cvt_pk_bf16_f32 v38, v244, v245
    v_cvt_pk_bf16_f32 v50, v248, v249
    v_cvt_pk_bf16_f32 v62, v252, v253
    v_cvt_pk_bf16_f32 v27, v242, v243
    v_cvt_pk_bf16_f32 v39, v246, v247
    v_cvt_pk_bf16_f32 v51, v250, v251
    v_cvt_pk_bf16_f32 v63, v254, v255
    v_mfma_f32_16x16x32_bf16 v[28:31], v[16:19], v[24:27], 0
    v_mfma_f32_16x16x32_bf16 v[40:43], v[16:19], v[36:39], 0
    v_mfma_f32_16x16x32_bf16 v[52:55], v[16:19], v[48:51], 0
    v_mfma_f32_16x16x32_bf16 v[64:67], v[16:19], v[60:63], 0
    v_mfma_f32_16x16x32_bf16 v[32:35], v[20:23], v[24:27], 0
    v_mfma_f32_16x16x32_bf16 v[44:47], v[20:23], v[36:39], 0
    v_mfma_f32_16x16x32_bf16 v[56:59], v[20:23], v[48:51], 0
    v_mfma_f32_16x16x32_bf16 v[68:71], v[20:23], v[60:63], 0
    s_add_u32 s56, s55, 16384
    v_mul_f32 v96, s34, v96
    v_mul_f32 v100, s34, v100
    s_nop 0
    v_mul_f32 v97, s34, v97
    v_mul_f32 v101, s34, v101
    s_nop 0
    v_mul_f32 v98, s34, v98
    v_mul_f32 v102, s34, v102
    s_nop 0
    v_mul_f32 v99, s34, v99
    v_mul_f32 v103, s34, v103
    s_nop 0
    v_mul_f32 v112, s34, v112
    v_mul_f32 v116, s34, v116
    s_nop 0
    v_mul_f32 v113, s34, v113
    v_mul_f32 v117, s34, v117
    s_nop 0
    v_mul_f32 v114, s34, v114
    v_mul_f32 v118, s34, v118
    s_nop 0
    v_mul_f32 v115, s34, v115
    v_exp_f32 v96, v96
    v_mul_f32 v119, s34, v119
    s_nop 0
    s_nop 0
    v_exp_f32 v97, v97
    s_nop 0
    s_nop 0
    s_nop 0
    v_exp_f32 v98, v98
    v_cvt_pk_bf16_f32 v24, v28, v29
    v_cvt_pk_bf16_f32 v25, v30, v31
    v_cvt_pk_bf16_f32 v26, v32, v33
    v_exp_f32 v99, v99
    v_cvt_pk_bf16_f32 v27, v34, v35
    buffer_store_dwordx4 v[24:27], v1, s[64:67], s58 offen offset:0 sc1
    v_cvt_pk_bf16_f32 v36, v40, v41
    v_exp_f32 v112, v112
    v_cvt_pk_bf16_f32 v37, v42, v43
    v_cvt_pk_bf16_f32 v38, v44, v45
    v_cvt_pk_bf16_f32 v39, v46, v47
    v_exp_f32 v113, v113
    buffer_store_dwordx4 v[36:39], v1, s[64:67], s58 offen offset:1024 sc1
    v_cvt_pk_bf16_f32 v48, v52, v53
    v_cvt_pk_bf16_f32 v49, v54, v55
    v_exp_f32 v114, v114
    v_cvt_pk_bf16_f32 v50, v56, v57
    v_cvt_pk_bf16_f32 v51, v58, v59
    buffer_store_dwordx4 v[48:51], v1, s[64:67], s58 offen offset:2048 sc1
    v_exp_f32 v115, v115
    v_cvt_pk_bf16_f32 v60, v64, v65
    v_add_f32 v96, 1.0, v96
    v_cvt_pk_bf16_f32 v61, v66, v67
    v_exp_f32 v100, v100
    v_cvt_pk_bf16_f32 v62, v68, v69
    v_add_f32 v97, 1.0, v97
    v_cvt_pk_bf16_f32 v63, v70, v71
    v_exp_f32 v101, v101
    buffer_store_dwordx4 v[60:63], v1, s[64:67], s58 offen offset:3072 sc1
    v_add_f32 v98, 1.0, v98
    v_add_f32 v99, 1.0, v99
    v_exp_f32 v102, v102
    v_add_f32 v112, 1.0, v112
    v_add_f32 v113, 1.0, v113
    v_add_f32 v114, 1.0, v114
    v_exp_f32 v103, v103
    v_add_f32 v115, 1.0, v115
    v_exp_f32 v116, v116
    v_rcp_f32 v96, v96
    v_exp_f32 v117, v117
    v_rcp_f32 v97, v97
    v_exp_f32 v118, v118
    v_rcp_f32 v98, v98
    v_exp_f32 v119, v119
    v_add_f32 v100, 1.0, v100
    v_add_f32 v101, 1.0, v101
    v_add_f32 v102, 1.0, v102
    v_rcp_f32 v99, v99
    v_add_f32 v103, 1.0, v103
    v_add_f32 v116, 1.0, v116
    v_add_f32 v117, 1.0, v117
    v_rcp_f32 v112, v112
    v_add_f32 v118, 1.0, v118
    v_add_f32 v119, 1.0, v119
    v_rcp_f32 v113, v113
    v_rcp_f32 v100, v100
    v_rcp_f32 v114, v114
    v_rcp_f32 v101, v101
    v_rcp_f32 v115, v115
    v_mul_f32 v96, v96, v128
    v_mul_f32 v97, v97, v129
    v_mul_f32 v98, v98, v130
    v_rcp_f32 v102, v102
    v_mul_f32 v99, v99, v131
    v_mul_f32 v112, v112, v144
    v_mul_f32 v113, v113, v145
    v_rcp_f32 v103, v103
    v_mul_f32 v114, v114, v146
    v_mul_f32 v115, v115, v147
    v_cvt_pk_bf16_f32 v72, v96, v97
    v_rcp_f32 v116, v116
    v_cvt_pk_bf16_f32 v73, v98, v99
    v_cvt_pk_bf16_f32 v74, v112, v113
    v_cvt_pk_bf16_f32 v75, v114, v115
    v_rcp_f32 v117, v117
    buffer_store_dwordx4 v[72:75], v1, s[64:67], s55 offen offset:0 sc1
    v_mul_f32 v104, s34, v104
    v_mul_f32 v105, s34, v105
    v_rcp_f32 v118, v118
    v_mul_f32 v106, s34, v106
    v_mul_f32 v107, s34, v107
    v_mul_f32 v120, s34, v120
    v_rcp_f32 v119, v119
    v_mul_f32 v121, s34, v121
    v_mul_f32 v100, v100, v132
    v_mul_f32 v122, s34, v122
    v_mul_f32 v101, v101, v133
    v_mul_f32 v123, s34, v123
    v_exp_f32 v104, v104
    v_mul_f32 v102, v102, v134
    v_mul_f32 v103, v103, v135
    v_mul_f32 v116, v116, v148
    v_exp_f32 v105, v105
    v_mul_f32 v117, v117, v149
    v_mul_f32 v118, v118, v150
    v_mul_f32 v119, v119, v151
    v_exp_f32 v106, v106
    v_cvt_pk_bf16_f32 v76, v100, v101
    v_cvt_pk_bf16_f32 v77, v102, v103
    v_cvt_pk_bf16_f32 v78, v116, v117
    v_exp_f32 v107, v107
    v_cvt_pk_bf16_f32 v79, v118, v119
    buffer_store_dwordx4 v[76:79], v1, s[64:67], s55 offen offset:1024 sc1
    v_mul_f32 v108, s34, v108
    v_exp_f32 v120, v120
    v_mul_f32 v109, s34, v109
    v_mul_f32 v110, s34, v110
    v_mul_f32 v111, s34, v111
    v_exp_f32 v121, v121
    v_mul_f32 v124, s34, v124
    v_mul_f32 v125, s34, v125
    v_mul_f32 v126, s34, v126
    v_exp_f32 v122, v122
    v_mul_f32 v127, s34, v127
    v_exp_f32 v123, v123
    v_add_f32 v104, 1.0, v104
    v_add_f32 v105, 1.0, v105
    v_add_f32 v106, 1.0, v106
    v_exp_f32 v108, v108
    v_add_f32 v107, 1.0, v107
    v_add_f32 v120, 1.0, v120
    v_add_f32 v121, 1.0, v121
    v_exp_f32 v109, v109
    v_add_f32 v122, 1.0, v122
    v_add_f32 v123, 1.0, v123
    v_exp_f32 v110, v110
    v_rcp_f32 v104, v104
    v_exp_f32 v111, v111
    v_rcp_f32 v105, v105
    v_exp_f32 v124, v124
    v_rcp_f32 v106, v106
    v_exp_f32 v125, v125
    v_rcp_f32 v107, v107
    v_exp_f32 v126, v126
    v_rcp_f32 v120, v120
    v_exp_f32 v127, v127
    v_add_f32 v108, 1.0, v108
    v_add_f32 v109, 1.0, v109
    v_add_f32 v110, 1.0, v110
    v_rcp_f32 v121, v121
    v_add_f32 v111, 1.0, v111
    v_add_f32 v124, 1.0, v124
    v_add_f32 v125, 1.0, v125
    v_rcp_f32 v122, v122
    v_add_f32 v126, 1.0, v126
    v_add_f32 v127, 1.0, v127
    v_rcp_f32 v123, v123
    v_mul_f32 v104, v104, v136
    v_mul_f32 v105, v105, v137
    v_mul_f32 v106, v106, v138
    v_rcp_f32 v108, v108
    v_mul_f32 v107, v107, v139
    v_mul_f32 v120, v120, v152
    v_mul_f32 v121, v121, v153
    v_rcp_f32 v109, v109
    v_mul_f32 v122, v122, v154
    v_mul_f32 v123, v123, v155
    v_cvt_pk_bf16_f32 v80, v104, v105
    v_rcp_f32 v110, v110
    v_cvt_pk_bf16_f32 v81, v106, v107
    v_cvt_pk_bf16_f32 v82, v120, v121
    v_cvt_pk_bf16_f32 v83, v122, v123
    v_rcp_f32 v111, v111
    buffer_store_dwordx4 v[80:83], v1, s[64:67], s55 offen offset:2048 sc1
    v_mul_f32 v160, s34, v160
    v_mul_f32 v161, s34, v161
    v_rcp_f32 v124, v124
    v_mul_f32 v162, s34, v162
    v_mul_f32 v163, s34, v163
    v_mul_f32 v176, s34, v176
    v_rcp_f32 v125, v125
    v_mul_f32 v177, s34, v177
    v_mul_f32 v178, s34, v178
    v_mul_f32 v179, s34, v179
    v_rcp_f32 v126, v126
    v_exp_f32 v160, v160
    v_rcp_f32 v127, v127
    v_mul_f32 v108, v108, v140
    v_mul_f32 v109, v109, v141
    v_mul_f32 v110, v110, v142
    v_exp_f32 v161, v161
    v_mul_f32 v111, v111, v143
    v_mul_f32 v124, v124, v156
    v_mul_f32 v125, v125, v157
    v_exp_f32 v162, v162
    v_mul_f32 v126, v126, v158
    v_mul_f32 v127, v127, v159
    v_cvt_pk_bf16_f32 v84, v108, v109
    v_exp_f32 v163, v163
    v_cvt_pk_bf16_f32 v85, v110, v111
    v_cvt_pk_bf16_f32 v86, v124, v125
    v_cvt_pk_bf16_f32 v87, v126, v127
    v_exp_f32 v176, v176
    buffer_store_dwordx4 v[84:87], v1, s[64:67], s55 offen offset:3072 sc1
    v_mul_f32 v164, s34, v164
    v_mul_f32 v165, s34, v165
    v_exp_f32 v177, v177
    v_mul_f32 v166, s34, v166
    v_mul_f32 v167, s34, v167
    v_mul_f32 v180, s34, v180
    v_exp_f32 v178, v178
    v_mul_f32 v181, s34, v181
    v_mul_f32 v182, s34, v182
    v_mul_f32 v183, s34, v183
    v_exp_f32 v179, v179
    v_add_f32 v160, 1.0, v160
    v_add_f32 v161, 1.0, v161
    v_add_f32 v162, 1.0, v162
    v_exp_f32 v164, v164
    v_add_f32 v163, 1.0, v163
    v_add_f32 v176, 1.0, v176
    v_add_f32 v177, 1.0, v177
    v_exp_f32 v165, v165
    v_add_f32 v178, 1.0, v178
    v_add_f32 v179, 1.0, v179
    v_exp_f32 v166, v166
    v_rcp_f32 v160, v160
    v_exp_f32 v167, v167
    v_rcp_f32 v161, v161
    v_exp_f32 v180, v180
    v_rcp_f32 v162, v162
    v_exp_f32 v181, v181
    v_rcp_f32 v163, v163
    v_exp_f32 v182, v182
    v_rcp_f32 v176, v176
    v_exp_f32 v183, v183
    v_add_f32 v164, 1.0, v164
    v_add_f32 v165, 1.0, v165
    v_add_f32 v166, 1.0, v166
    v_rcp_f32 v177, v177
    v_add_f32 v167, 1.0, v167
    v_add_f32 v180, 1.0, v180
    v_add_f32 v181, 1.0, v181
    v_rcp_f32 v178, v178
    v_add_f32 v182, 1.0, v182
    v_add_f32 v183, 1.0, v183
    v_rcp_f32 v179, v179
    v_mul_f32 v160, v160, v192
    v_mul_f32 v161, v161, v193
    v_mul_f32 v162, v162, v194
    v_rcp_f32 v164, v164
    v_mul_f32 v163, v163, v195
    v_mul_f32 v176, v176, v208
    v_mul_f32 v177, v177, v209
    v_rcp_f32 v165, v165
    v_mul_f32 v178, v178, v210
    v_mul_f32 v179, v179, v211
    v_cvt_pk_bf16_f32 v224, v160, v161
    v_rcp_f32 v166, v166
    v_cvt_pk_bf16_f32 v225, v162, v163
    v_cvt_pk_bf16_f32 v226, v176, v177
    v_cvt_pk_bf16_f32 v227, v178, v179
    v_rcp_f32 v167, v167
    buffer_store_dwordx4 v[224:227], v1, s[64:67], s56 offen offset:0 sc1
    v_mul_f32 v168, s34, v168
    v_mul_f32 v169, s34, v169
    v_rcp_f32 v180, v180
    v_mul_f32 v170, s34, v170
    v_mul_f32 v171, s34, v171
    v_mul_f32 v184, s34, v184
    v_rcp_f32 v181, v181
    v_mul_f32 v185, s34, v185
    v_mul_f32 v186, s34, v186
    v_mul_f32 v187, s34, v187
    v_rcp_f32 v182, v182
    v_exp_f32 v168, v168
    v_rcp_f32 v183, v183
    v_mul_f32 v164, v164, v196
    v_mul_f32 v165, v165, v197
    v_mul_f32 v166, v166, v198
    v_exp_f32 v169, v169
    v_mul_f32 v167, v167, v199
    v_mul_f32 v180, v180, v212
    v_mul_f32 v181, v181, v213
    v_exp_f32 v170, v170
    v_mul_f32 v182, v182, v214
    v_mul_f32 v183, v183, v215
    v_cvt_pk_bf16_f32 v228, v164, v165
    v_exp_f32 v171, v171
    v_cvt_pk_bf16_f32 v229, v166, v167
    v_cvt_pk_bf16_f32 v230, v180, v181
    v_cvt_pk_bf16_f32 v231, v182, v183
    v_exp_f32 v184, v184
    buffer_store_dwordx4 v[228:231], v1, s[64:67], s56 offen offset:1024 sc1
    v_mul_f32 v172, s34, v172
    v_mul_f32 v173, s34, v173
    v_exp_f32 v185, v185
    v_mul_f32 v174, s34, v174
    v_mul_f32 v175, s34, v175
    v_mul_f32 v188, s34, v188
    v_exp_f32 v186, v186
    v_mul_f32 v189, s34, v189
    v_mul_f32 v190, s34, v190
    v_mul_f32 v191, s34, v191
    v_exp_f32 v187, v187
    v_add_f32 v168, 1.0, v168
    v_add_f32 v169, 1.0, v169
    v_add_f32 v170, 1.0, v170
    v_exp_f32 v172, v172
    v_add_f32 v171, 1.0, v171
    v_add_f32 v184, 1.0, v184
    v_add_f32 v185, 1.0, v185
    v_exp_f32 v173, v173
    v_add_f32 v186, 1.0, v186
    v_add_f32 v187, 1.0, v187
    v_exp_f32 v174, v174
    v_rcp_f32 v168, v168
    v_exp_f32 v175, v175
    v_rcp_f32 v169, v169
    v_exp_f32 v188, v188
    v_rcp_f32 v170, v170
    v_exp_f32 v189, v189
    v_rcp_f32 v171, v171
    v_exp_f32 v190, v190
    v_rcp_f32 v184, v184
    v_exp_f32 v191, v191
    v_add_f32 v172, 1.0, v172
    v_add_f32 v173, 1.0, v173
    v_add_f32 v174, 1.0, v174
    v_rcp_f32 v185, v185
    v_add_f32 v175, 1.0, v175
    v_add_f32 v188, 1.0, v188
    v_add_f32 v189, 1.0, v189
    v_rcp_f32 v186, v186
    v_add_f32 v190, 1.0, v190
    v_add_f32 v191, 1.0, v191
    v_rcp_f32 v187, v187
    v_mul_f32 v168, v168, v200
    v_mul_f32 v169, v169, v201
    v_mul_f32 v170, v170, v202
    v_rcp_f32 v172, v172
    v_mul_f32 v171, v171, v203
    v_mul_f32 v184, v184, v216
    v_mul_f32 v185, v185, v217
    v_rcp_f32 v173, v173
    v_mul_f32 v186, v186, v218
    v_mul_f32 v187, v187, v219
    v_cvt_pk_bf16_f32 v232, v168, v169
    v_rcp_f32 v174, v174
    v_cvt_pk_bf16_f32 v233, v170, v171
    v_cvt_pk_bf16_f32 v234, v184, v185
    v_cvt_pk_bf16_f32 v235, v186, v187
    v_rcp_f32 v175, v175
    buffer_store_dwordx4 v[232:235], v1, s[64:67], s56 offen offset:2048 sc1
    v_rcp_f32 v188, v188
    v_rcp_f32 v189, v189
    v_rcp_f32 v190, v190
    v_rcp_f32 v191, v191
    v_mul_f32 v172, v172, v204
    v_mul_f32 v173, v173, v205
    v_mul_f32 v174, v174, v206
    v_mul_f32 v175, v175, v207
    v_mul_f32 v188, v188, v220
    v_mul_f32 v189, v189, v221
    v_mul_f32 v190, v190, v222
    v_mul_f32 v191, v191, v223
    v_cvt_pk_bf16_f32 v236, v172, v173
    v_cvt_pk_bf16_f32 v237, v174, v175
    v_cvt_pk_bf16_f32 v238, v188, v189
    v_cvt_pk_bf16_f32 v239, v190, v191
    buffer_store_dwordx4 v[236:239], v1, s[64:67], s56 offen offset:3072 sc1
    s_branch G1_end
G1_T2:
    s_barrier
    v_and_b32 v2, 15, v15
    v_lshrrev_b32 v3, 4, v15
    v_and_b32 v4, 6, v2
    v_lshrrev_b32 v5, 1, v3
    v_xor_b32 v5, v5, v4
    v_and_b32 v6, 1, v3
    v_lshlrev_b32 v6, 3, v6
    s_lshl_b32 s58, s53, 15
    s_lshl_b32 s59, s52, 13
    s_add_u32 s58, s58, s59
    v_lshl_add_u32 v7, v2, 7, v6
    v_add_u32 v7, s58, v7
    v_xor_b32 v8, 0, v5
    v_lshl_add_u32 v9, v8, 4, v7
    v_xor_b32 v8, 2, v5
    v_lshl_add_u32 v10, v8, 4, v7
    v_xor_b32 v8, 4, v5
    v_lshl_add_u32 v11, v8, 4, v7
    v_xor_b32 v8, 6, v5
    v_lshl_add_u32 v12, v8, 4, v7
    v_lshrrev_b32 v8, 1, v2
    v_and_b32 v8, 2, v8
    v_lshrrev_b32 v5, 1, v3
    v_xor_b32 v5, v5, v8
    s_lshl_b32 s58, s53, 14
    s_lshl_b32 s59, s52, 12
    s_add_u32 s58, s58, s59
    s_add_u32 s58, s58, 65536
    v_lshl_add_u32 v7, v2, 6, v6
    v_add_u32 v7, s58, v7
    v_xor_b32 v8, 0, v5
    v_lshl_add_u32 v13, v8, 4, v7
    v_xor_b32 v8, 2, v5
    v_lshl_add_u32 v14, v8, 4, v7
    v_cvt_pk_bf16_f32 v88, v192, v193
    v_cvt_pk_bf16_f32 v89, v194, v195
    ds_write_b64 v13, v[88:89] offset:0
    v_cvt_pk_bf16_f32 v90, v208, v209
    v_cvt_pk_bf16_f32 v91, v210, v211
    ds_write_b64 v14, v[90:91] offset:0
    v_cvt_pk_bf16_f32 v92, v196, v197
    v_cvt_pk_bf16_f32 v93, v198, v199
    ds_write_b64 v13, v[92:93] offset:1024
    v_cvt_pk_bf16_f32 v94, v212, v213
    v_cvt_pk_bf16_f32 v95, v214, v215
    ds_write_b64 v14, v[94:95] offset:1024
    v_cvt_pk_bf16_f32 v88, v200, v201
    v_cvt_pk_bf16_f32 v89, v202, v203
    ds_write_b64 v13, v[88:89] offset:2048
    v_cvt_pk_bf16_f32 v90, v216, v217
    v_cvt_pk_bf16_f32 v91, v218, v219
    ds_write_b64 v14, v[90:91] offset:2048
    v_cvt_pk_bf16_f32 v92, v204, v205
    v_cvt_pk_bf16_f32 v93, v206, v207
    ds_write_b64 v13, v[92:93] offset:3072
    v_cvt_pk_bf16_f32 v94, v220, v221
    v_cvt_pk_bf16_f32 v95, v222, v223
    ds_write_b64 v14, v[94:95] offset:3072
    v_cvt_pk_bf16_f32 v24, v160, v161
    v_cvt_pk_bf16_f32 v25, v162, v163
    v_cvt_pk_bf16_f32 v26, v176, v177
    v_cvt_pk_bf16_f32 v27, v178, v179
    v_cvt_pk_bf16_f32 v56, v164, v165
    v_cvt_pk_bf16_f32 v57, v166, v167
    v_cvt_pk_bf16_f32 v58, v180, v181
    v_cvt_pk_bf16_f32 v59, v182, v183
    v_cvt_pk_bf16_f32 v88, v168, v169
    v_cvt_pk_bf16_f32 v89, v170, v171
    v_cvt_pk_bf16_f32 v90, v184, v185
    v_cvt_pk_bf16_f32 v91, v186, v187
    v_cvt_pk_bf16_f32 v92, v172, v173
    v_cvt_pk_bf16_f32 v93, v174, v175
    v_cvt_pk_bf16_f32 v94, v188, v189
    v_cvt_pk_bf16_f32 v95, v190, v191
    v_mfma_f32_16x16x32_bf16 v[28:31], v[16:19], v[24:27], 0
    v_mfma_f32_16x16x32_bf16 v[32:35], v[20:23], v[24:27], 0
    v_mfma_f32_16x16x32_bf16 v[60:63], v[16:19], v[56:59], 0
    v_mfma_f32_16x16x32_bf16 v[64:67], v[20:23], v[56:59], 0
    v_mfma_f32_16x16x32_bf16 v[164:167], v[16:19], v[88:91], 0
    v_mfma_f32_16x16x32_bf16 v[168:171], v[20:23], v[88:91], 0
    v_mfma_f32_16x16x32_bf16 v[196:199], v[16:19], v[92:95], 0
    v_mfma_f32_16x16x32_bf16 v[200:203], v[20:23], v[92:95], 0
    v_mul_f32 v96, s34, v96
    v_mul_f32 v97, s34, v97
    v_mul_f32 v98, s34, v98
    v_mul_f32 v99, s34, v99
    v_mul_f32 v112, s34, v112
    v_mul_f32 v113, s34, v113
    v_mul_f32 v114, s34, v114
    v_mul_f32 v115, s34, v115
    v_mul_f32 v100, s34, v100
    v_mul_f32 v101, s34, v101
    v_mul_f32 v102, s34, v102
    v_mul_f32 v103, s34, v103
    v_exp_f32 v96, v96
    v_mul_f32 v116, s34, v116
    v_max3_f32 v44, v28, v29, v30
    v_max3_f32 v76, v60, v61, v62
    v_exp_f32 v97, v97
    v_mul_f32 v117, s34, v117
    v_min3_f32 v45, v28, v29, v30
    v_min3_f32 v77, v60, v61, v62
    v_exp_f32 v98, v98
    v_mul_f32 v118, s34, v118
    v_max3_f32 v46, v31, v32, v33
    v_max3_f32 v78, v63, v64, v65
    v_exp_f32 v99, v99
    v_mul_f32 v119, s34, v119
    v_min3_f32 v47, v31, v32, v33
    v_min3_f32 v79, v63, v64, v65
    v_exp_f32 v112, v112
    v_max3_f32 v44, v44, v34, v35
    v_max3_f32 v76, v76, v66, v67
    v_max3_f32 v180, v164, v165, v166
    v_exp_f32 v113, v113
    v_min3_f32 v45, v45, v34, v35
    v_min3_f32 v77, v77, v66, v67
    v_min3_f32 v181, v164, v165, v166
    v_exp_f32 v114, v114
    v_max_f32 v44, v44, v46
    v_max_f32 v76, v76, v78
    v_max3_f32 v182, v167, v168, v169
    v_exp_f32 v115, v115
    v_max_f32 v45, -v45, -v47
    v_max_f32 v77, -v77, -v79
    v_min3_f32 v183, v167, v168, v169
    v_exp_f32 v100, v100
    v_permlane16_swap_b32 v44, v45
    v_permlane16_swap_b32 v76, v77
    v_max3_f32 v180, v180, v170, v171
    v_exp_f32 v101, v101
    v_max_f32 v44, v44, v45
    v_max_f32 v76, v76, v77
    v_min3_f32 v181, v181, v170, v171
    v_exp_f32 v102, v102
    v_mov_b32 v45, v44
    v_mov_b32 v77, v76
    v_max_f32 v180, v180, v182
    v_exp_f32 v103, v103
    v_permlane32_swap_b32 v44, v45
    v_permlane32_swap_b32 v76, v77
    v_max_f32 v181, -v181, -v183
    v_exp_f32 v116, v116
    v_max_f32 v44, v44, v45
    v_max_f32 v76, v76, v77
    v_permlane16_swap_b32 v180, v181
    v_exp_f32 v117, v117
    v_mov_b32 v45, v44
    v_mov_b32 v77, v76
    v_max_f32 v180, v180, v181
    v_exp_f32 v118, v118
    v_permlane16_swap_b32 v44, v45
    v_permlane16_swap_b32 v76, v77
    v_mov_b32 v181, v180
    v_exp_f32 v119, v119
    v_mul_f32 v46, s32, v44
    v_mul_f32 v78, s32, v76
    v_permlane32_swap_b32 v180, v181
    v_max3_f32 v212, v196, v197, v198
    v_add_f32 v96, 1.0, v96
    v_add_f32 v100, 1.0, v100
    v_mul_f32 v47, s32, v45
    v_mul_f32 v79, s32, v77
    v_max_f32 v180, v180, v181
    v_min3_f32 v213, v196, v197, v198
    v_add_f32 v97, 1.0, v97
    v_add_f32 v101, 1.0, v101
    v_fma_f32 v36, -v28, s32, -v47
    v_fma_f32 v68, -v60, s32, -v79
    v_mov_b32 v181, v180
    v_max3_f32 v214, v199, v200, v201
    v_add_f32 v98, 1.0, v98
    v_add_f32 v102, 1.0, v102
    v_fma_f32 v28, v28, s32, -v46
    v_fma_f32 v60, v60, s32, -v78
    v_permlane16_swap_b32 v180, v181
    v_min3_f32 v215, v199, v200, v201
    v_add_f32 v99, 1.0, v99
    v_add_f32 v103, 1.0, v103
    v_fma_f32 v37, -v29, s32, -v47
    v_fma_f32 v69, -v61, s32, -v79
    v_mul_f32 v182, s32, v180
    v_max3_f32 v212, v212, v202, v203
    v_add_f32 v112, 1.0, v112
    v_add_f32 v116, 1.0, v116
    v_fma_f32 v29, v29, s32, -v46
    v_fma_f32 v61, v61, s32, -v78
    v_mul_f32 v183, s32, v181
    v_min3_f32 v213, v213, v202, v203
    v_add_f32 v113, 1.0, v113
    v_add_f32 v117, 1.0, v117
    v_fma_f32 v38, -v30, s32, -v47
    v_fma_f32 v70, -v62, s32, -v79
    v_fma_f32 v172, -v164, s32, -v183
    v_max_f32 v212, v212, v214
    v_add_f32 v114, 1.0, v114
    v_add_f32 v118, 1.0, v118
    v_fma_f32 v30, v30, s32, -v46
    v_fma_f32 v62, v62, s32, -v78
    v_fma_f32 v164, v164, s32, -v182
    v_max_f32 v213, -v213, -v215
    v_add_f32 v115, 1.0, v115
    v_rcp_f32 v96, v96
    v_add_f32 v119, 1.0, v119
    v_fma_f32 v39, -v31, s32, -v47
    v_fma_f32 v71, -v63, s32, -v79
    v_rcp_f32 v97, v97
    v_fma_f32 v31, v31, s32, -v46
    v_fma_f32 v63, v63, s32, -v78
    v_fma_f32 v173, -v165, s32, -v183
    v_rcp_f32 v98, v98
    v_fma_f32 v40, -v32, s32, -v47
    v_fma_f32 v72, -v64, s32, -v79
    v_fma_f32 v165, v165, s32, -v182
    v_rcp_f32 v99, v99
    v_fma_f32 v32, v32, s32, -v46
    v_fma_f32 v64, v64, s32, -v78
    v_fma_f32 v174, -v166, s32, -v183
    v_rcp_f32 v112, v112
    v_fma_f32 v41, -v33, s32, -v47
    v_fma_f32 v73, -v65, s32, -v79
    v_fma_f32 v166, v166, s32, -v182
    v_rcp_f32 v113, v113
    v_fma_f32 v33, v33, s32, -v46
    v_fma_f32 v65, v65, s32, -v78
    v_fma_f32 v175, -v167, s32, -v183
    v_rcp_f32 v114, v114
    v_fma_f32 v42, -v34, s32, -v47
    v_fma_f32 v74, -v66, s32, -v79
    v_fma_f32 v167, v167, s32, -v182
    v_rcp_f32 v115, v115
    v_fma_f32 v34, v34, s32, -v46
    v_fma_f32 v66, v66, s32, -v78
    v_fma_f32 v176, -v168, s32, -v183
    v_rcp_f32 v100, v100
    v_fma_f32 v43, -v35, s32, -v47
    v_fma_f32 v75, -v67, s32, -v79
    v_fma_f32 v168, v168, s32, -v182
    v_rcp_f32 v101, v101
    v_fma_f32 v35, v35, s32, -v46
    v_fma_f32 v67, v67, s32, -v78
    v_fma_f32 v177, -v169, s32, -v183
    v_rcp_f32 v102, v102
    v_fma_f32 v169, v169, s32, -v182
    v_permlane16_swap_b32 v212, v213
    v_mul_f32 v96, v96, v128
    v_rcp_f32 v103, v103
    v_fma_f32 v178, -v170, s32, -v183
    v_max_f32 v212, v212, v213
    v_mul_f32 v97, v97, v129
    v_rcp_f32 v116, v116
    v_fma_f32 v170, v170, s32, -v182
    v_mov_b32 v213, v212
    v_mul_f32 v98, v98, v130
    v_rcp_f32 v117, v117
    v_fma_f32 v179, -v171, s32, -v183
    v_permlane32_swap_b32 v212, v213
    v_mul_f32 v99, v99, v131
    v_rcp_f32 v118, v118
    v_fma_f32 v171, v171, s32, -v182
    v_max_f32 v212, v212, v213
    v_mul_f32 v112, v112, v144
    v_rcp_f32 v119, v119
    v_mov_b32 v213, v212
    v_mul_f32 v113, v113, v145
    v_mul_f32 v100, v100, v132
    v_exp_f32 v28, v28
    v_permlane16_swap_b32 v212, v213
    v_mul_f32 v114, v114, v146
    v_mul_f32 v101, v101, v133
    v_exp_f32 v36, v36
    v_mul_f32 v214, s32, v212
    v_mul_f32 v115, v115, v147
    v_mul_f32 v102, v102, v134
    v_exp_f32 v29, v29
    v_mul_f32 v215, s32, v213
    v_cvt_pk_bf16_f32 v88, v96, v97
    v_mul_f32 v103, v103, v135
    v_exp_f32 v37, v37
    v_fma_f32 v204, -v196, s32, -v215
    v_cvt_pk_bf16_f32 v89, v98, v99
    v_mul_f32 v116, v116, v148
    v_exp_f32 v30, v30
    v_fma_f32 v196, v196, s32, -v214
    v_cvt_pk_bf16_f32 v90, v112, v113
    v_mul_f32 v117, v117, v149
    v_exp_f32 v38, v38
    v_fma_f32 v205, -v197, s32, -v215
    v_cvt_pk_bf16_f32 v91, v114, v115
    v_mul_f32 v118, v118, v150
    v_exp_f32 v31, v31
    v_fma_f32 v197, v197, s32, -v214
    buffer_store_dwordx4 v[88:91], v1, s[64:67], s55 offen offset:0 sc1
    v_mul_f32 v119, v119, v151
    v_exp_f32 v39, v39
    v_fma_f32 v206, -v198, s32, -v215
    v_cvt_pk_bf16_f32 v92, v100, v101
    v_fma_f32 v198, v198, s32, -v214
    v_exp_f32 v32, v32
    v_fma_f32 v207, -v199, s32, -v215
    v_cvt_pk_bf16_f32 v93, v102, v103
    v_fma_f32 v199, v199, s32, -v214
    v_exp_f32 v40, v40
    v_fma_f32 v208, -v200, s32, -v215
    v_cvt_pk_bf16_f32 v94, v116, v117
    v_fma_f32 v200, v200, s32, -v214
    v_exp_f32 v33, v33
    v_fma_f32 v209, -v201, s32, -v215
    v_cvt_pk_bf16_f32 v95, v118, v119
    v_fma_f32 v201, v201, s32, -v214
    v_exp_f32 v41, v41
    v_fma_f32 v210, -v202, s32, -v215
    buffer_store_dwordx4 v[92:95], v1, s[64:67], s55 offen offset:1024 sc1
    v_fma_f32 v202, v202, s32, -v214
    v_exp_f32 v34, v34
    v_fma_f32 v211, -v203, s32, -v215
    v_fma_f32 v203, v203, s32, -v214
    v_exp_f32 v42, v42
    v_exp_f32 v60, v60
    v_exp_f32 v164, v164
    v_exp_f32 v196, v196
    v_exp_f32 v35, v35
    v_exp_f32 v68, v68
    v_exp_f32 v172, v172
    v_exp_f32 v204, v204
    v_exp_f32 v43, v43
    v_add_f32 v44, v28, v29
    v_add_f32 v45, v36, v37
    v_add_f32 v46, v30, v31
    v_exp_f32 v61, v61
    v_add_f32 v47, v38, v39
    v_add_f32 v44, v44, v32
    v_add_f32 v45, v45, v40
    v_exp_f32 v69, v69
    v_add_f32 v46, v46, v33
    v_add_f32 v47, v47, v41
    v_add_f32 v44, v44, v34
    v_exp_f32 v62, v62
    v_add_f32 v45, v45, v42
    v_add_f32 v46, v46, v35
    v_add_f32 v47, v47, v43
    v_exp_f32 v70, v70
    v_add_f32 v44, v44, v46
    v_add_f32 v45, v45, v47
    s_nop 1
    v_permlane16_swap_b32 v44, v45
    v_exp_f32 v63, v63
    v_add_f32 v44, v44, v45
    v_mov_b32 v45, v44
    s_nop 1
    v_permlane32_swap_b32 v44, v45
    v_exp_f32 v71, v71
    v_add_f32 v44, v44, v45
    v_mov_b32 v45, v44
    s_nop 1
    v_permlane16_swap_b32 v44, v45
    v_exp_f32 v64, v64
    v_exp_f32 v165, v165
    v_exp_f32 v197, v197
    v_rcp_f32 v44, v44
    v_exp_f32 v72, v72
    v_exp_f32 v173, v173
    v_exp_f32 v205, v205
    v_rcp_f32 v45, v45
    v_mul_f32 v28, v28, v44
    v_mul_f32 v36, v36, v45
    v_mul_f32 v29, v29, v44
    v_exp_f32 v65, v65
    v_mul_f32 v37, v37, v45
    v_mul_f32 v30, v30, v44
    v_mul_f32 v38, v38, v45
    v_exp_f32 v73, v73
    v_mul_f32 v31, v31, v44
    v_mul_f32 v39, v39, v45
    v_mul_f32 v32, v32, v44
    v_exp_f32 v66, v66
    v_mul_f32 v40, v40, v45
    v_mul_f32 v33, v33, v44
    v_mul_f32 v41, v41, v45
    v_exp_f32 v74, v74
    v_mul_f32 v34, v34, v44
    v_mul_f32 v42, v42, v45
    v_mul_f32 v35, v35, v44
    v_exp_f32 v67, v67
    v_mul_f32 v43, v43, v45
    v_cvt_pk_bf16_f32 v48, v28, v29
    v_cvt_pk_bf16_f32 v52, v36, v37
    v_exp_f32 v75, v75
    v_cvt_pk_bf16_f32 v49, v30, v31
    v_add_f32 v76, v60, v61
    v_cvt_pk_bf16_f32 v53, v38, v39
    v_exp_f32 v166, v166
    v_cvt_pk_bf16_f32 v50, v32, v33
    v_add_f32 v77, v68, v69
    v_cvt_pk_bf16_f32 v54, v40, v41
    v_exp_f32 v174, v174
    v_cvt_pk_bf16_f32 v51, v34, v35
    v_add_f32 v78, v62, v63
    v_cvt_pk_bf16_f32 v55, v42, v43
    v_exp_f32 v167, v167
    ds_write_b64 v9, v[48:49] offset:0
    v_add_f32 v79, v70, v71
    ds_write_b64 v10, v[50:51] offset:0
    v_exp_f32 v175, v175
    ds_write_b64 v11, v[52:53] offset:0
    v_add_f32 v76, v76, v64
    ds_write_b64 v12, v[54:55] offset:0
    v_exp_f32 v168, v168
    v_add_f32 v77, v77, v72
    v_add_f32 v78, v78, v65
    v_add_f32 v79, v79, v73
    v_exp_f32 v176, v176
    v_add_f32 v76, v76, v66
    v_add_f32 v77, v77, v74
    v_add_f32 v78, v78, v67
    v_exp_f32 v169, v169
    v_add_f32 v79, v79, v75
    v_add_f32 v76, v76, v78
    v_add_f32 v77, v77, v79
    v_exp_f32 v177, v177
    s_nop 0
    v_permlane16_swap_b32 v76, v77
    v_add_f32 v76, v76, v77
    v_mov_b32 v77, v76
    v_exp_f32 v170, v170
    s_nop 0
    v_permlane32_swap_b32 v76, v77
    v_add_f32 v76, v76, v77
    v_mov_b32 v77, v76
    v_exp_f32 v178, v178
    s_nop 0
    v_permlane16_swap_b32 v76, v77
    v_exp_f32 v171, v171
    v_exp_f32 v198, v198
    v_rcp_f32 v76, v76
    v_exp_f32 v179, v179
    v_add_f32 v180, v164, v165
    v_add_f32 v181, v172, v173
    v_add_f32 v182, v166, v167
    v_exp_f32 v206, v206
    v_add_f32 v183, v174, v175
    v_add_f32 v180, v180, v168
    v_add_f32 v181, v181, v176
    v_exp_f32 v199, v199
    v_add_f32 v182, v182, v169
    v_add_f32 v183, v183, v177
    v_add_f32 v180, v180, v170
    v_exp_f32 v207, v207
    v_add_f32 v181, v181, v178
    v_add_f32 v182, v182, v171
    v_add_f32 v183, v183, v179
    v_exp_f32 v200, v200
    v_add_f32 v180, v180, v182
    v_add_f32 v181, v181, v183
    s_nop 1
    v_permlane16_swap_b32 v180, v181
    v_exp_f32 v208, v208
    v_add_f32 v180, v180, v181
    v_mov_b32 v181, v180
    s_nop 1
    v_permlane32_swap_b32 v180, v181
    v_exp_f32 v201, v201
    v_add_f32 v180, v180, v181
    v_mov_b32 v181, v180
    s_nop 1
    v_permlane16_swap_b32 v180, v181
    v_exp_f32 v209, v209
    v_rcp_f32 v77, v77
    v_mul_f32 v60, v60, v76
    v_mul_f32 v68, v68, v77
    v_mul_f32 v61, v61, v76
    v_rcp_f32 v180, v180
    v_mul_f32 v69, v69, v77
    v_mul_f32 v62, v62, v76
    v_mul_f32 v70, v70, v77
    v_rcp_f32 v181, v181
    v_mul_f32 v63, v63, v76
    v_mul_f32 v164, v164, v180
    v_mul_f32 v71, v71, v77
    v_exp_f32 v202, v202
    v_mul_f32 v64, v64, v76
    v_mul_f32 v172, v172, v181
    v_mul_f32 v72, v72, v77
    v_exp_f32 v210, v210
    v_mul_f32 v65, v65, v76
    v_mul_f32 v165, v165, v180
    v_mul_f32 v73, v73, v77
    v_exp_f32 v203, v203
    v_mul_f32 v66, v66, v76
    v_mul_f32 v173, v173, v181
    v_mul_f32 v74, v74, v77
    v_exp_f32 v211, v211
    v_mul_f32 v67, v67, v76
    v_mul_f32 v166, v166, v180
    v_add_f32 v212, v196, v197
    v_mul_f32 v75, v75, v77
    v_mul_f32 v174, v174, v181
    v_add_f32 v213, v204, v205
    v_cvt_pk_bf16_f32 v80, v60, v61
    v_mul_f32 v167, v167, v180
    v_add_f32 v214, v198, v199
    v_cvt_pk_bf16_f32 v84, v68, v69
    v_mul_f32 v175, v175, v181
    v_add_f32 v215, v206, v207
    v_cvt_pk_bf16_f32 v81, v62, v63
    v_mul_f32 v168, v168, v180
    v_add_f32 v212, v212, v200
    v_cvt_pk_bf16_f32 v85, v70, v71
    v_mul_f32 v176, v176, v181
    v_add_f32 v213, v213, v208
    v_cvt_pk_bf16_f32 v82, v64, v65
    v_mul_f32 v169, v169, v180
    v_add_f32 v214, v214, v201
    v_cvt_pk_bf16_f32 v86, v72, v73
    v_mul_f32 v177, v177, v181
    v_add_f32 v215, v215, v209
    v_cvt_pk_bf16_f32 v83, v66, v67
    v_mul_f32 v170, v170, v180
    v_add_f32 v212, v212, v202
    v_cvt_pk_bf16_f32 v87, v74, v75
    v_mul_f32 v178, v178, v181
    v_add_f32 v213, v213, v210
    ds_write_b64 v9, v[80:81] offset:2048
    v_mul_f32 v171, v171, v180
    v_add_f32 v214, v214, v203
    ds_write_b64 v10, v[82:83] offset:2048
    v_mul_f32 v179, v179, v181
    v_add_f32 v215, v215, v211
    ds_write_b64 v11, v[84:85] offset:2048
    v_cvt_pk_bf16_f32 v184, v164, v165
    v_add_f32 v212, v212, v214
    ds_write_b64 v12, v[86:87] offset:2048
    v_cvt_pk_bf16_f32 v188, v172, v173
    v_add_f32 v213, v213, v215
    v_cvt_pk_bf16_f32 v185, v166, v167
    s_nop 0
    v_permlane16_swap_b32 v212, v213
    v_cvt_pk_bf16_f32 v189, v174, v175
    v_add_f32 v212, v212, v213
    v_cvt_pk_bf16_f32 v186, v168, v169
    v_mov_b32 v213, v212
    v_cvt_pk_bf16_f32 v190, v176, v177
    s_nop 0
    v_permlane32_swap_b32 v212, v213
    v_cvt_pk_bf16_f32 v187, v170, v171
    v_add_f32 v212, v212, v213
    v_cvt_pk_bf16_f32 v191, v178, v179
    v_mov_b32 v213, v212
    ds_write_b64 v9, v[184:185] offset:4096
    s_nop 0
    v_permlane16_swap_b32 v212, v213
    v_rcp_f32 v212, v212
    ds_write_b64 v10, v[186:187] offset:4096
    ds_write_b64 v11, v[188:189] offset:4096
    ds_write_b64 v12, v[190:191] offset:4096
    v_rcp_f32 v213, v213
    v_mul_f32 v196, v196, v212
    v_mul_f32 v204, v204, v213
    v_mul_f32 v197, v197, v212
    v_mul_f32 v205, v205, v213
    v_mul_f32 v198, v198, v212
    v_mul_f32 v206, v206, v213
    v_mul_f32 v199, v199, v212
    v_mul_f32 v207, v207, v213
    v_mul_f32 v200, v200, v212
    v_mul_f32 v208, v208, v213
    v_mul_f32 v201, v201, v212
    v_mul_f32 v209, v209, v213
    v_mul_f32 v202, v202, v212
    v_mul_f32 v210, v210, v213
    v_mul_f32 v203, v203, v212
    v_mul_f32 v211, v211, v213
    v_cvt_pk_bf16_f32 v216, v196, v197
    v_cvt_pk_bf16_f32 v220, v204, v205
    v_cvt_pk_bf16_f32 v217, v198, v199
    v_cvt_pk_bf16_f32 v221, v206, v207
    v_cvt_pk_bf16_f32 v218, v200, v201
    v_cvt_pk_bf16_f32 v222, v208, v209
    v_cvt_pk_bf16_f32 v219, v202, v203
    v_cvt_pk_bf16_f32 v223, v210, v211
    ds_write_b64 v9, v[216:217] offset:6144
    ds_write_b64 v10, v[218:219] offset:6144
    ds_write_b64 v11, v[220:221] offset:6144
    ds_write_b64 v12, v[222:223] offset:6144
    v_lshrrev_b32 v4, 2, v15
    v_and_b32 v4, 3, v4
    v_and_b32 v5, 3, v15
    v_lshl_add_u32 v6, v3, 2, v4
    v_and_b32 v7, 6, v6
    v_lshrrev_b32 v8, 1, v5
    s_lshl_b32 s58, s52, 1
    v_add_u32 v8, s58, v8
    v_xor_b32 v8, v8, v7
    v_and_b32 v9, 1, v5
    v_lshlrev_b32 v9, 3, v9
    v_lshl_add_u32 v10, v6, 7, v9
    v_lshl_add_u32 v10, v8, 4, v10
    s_lshl_b32 s58, s53, 15
    v_add_u32 v10, s58, v10
    v_lshrrev_b32 v7, 1, v6
    v_and_b32 v7, 2, v7
    v_lshrrev_b32 v8, 1, v5
    v_xor_b32 v8, v8, v7
    v_lshl_add_u32 v11, v6, 6, v9
    s_lshl_b32 s58, s53, 14
    s_add_u32 s58, s58, 65536
    v_add_u32 v11, s58, v11
    v_xor_b32 v7, 2, v8
    v_lshl_add_u32 v12, v7, 4, v11
    v_lshl_add_u32 v11, v8, 4, v11
    v_mov_b32 v20, 0x3f803f80
    v_mov_b32 v21, 0x3f803f80
    v_mov_b32 v22, 0x3f803f80
    v_mov_b32 v23, 0x3f803f80
    v_mov_b32 v24, 0
    v_mov_b32 v25, 0
    v_mov_b32 v26, 0
    v_mov_b32 v27, 0
    v_mov_b32 v28, 0
    v_mov_b32 v29, 0
    v_mov_b32 v30, 0
    v_mov_b32 v31, 0
    v_mov_b32 v32, 0
    v_mov_b32 v33, 0
    v_mov_b32 v34, 0
    v_mov_b32 v35, 0
    s_mul_i32 s58, s57, 9216
    s_add_u32 s58, s58, 50331648
    s_lshl_b32 s59, s52, 6
    s_add_u32 s59, s59, s58
    s_add_u32 s59, s59, 8192
    s_lshl_b32 s56, s52, 11
    s_add_u32 s58, s58, s56
    v_lshlrev_b32 v2, 4, v3
    v_lshlrev_b32 v4, 2, v15
    s_waitcnt lgkmcnt(0)
    s_barrier
    ds_read_b64_tr_b16 v[36:37], v10 offset:0
    ds_read_b64_tr_b16 v[38:39], v10 offset:2048
    ds_read_b64_tr_b16 v[40:41], v11 offset:0
    ds_read_b64_tr_b16 v[42:43], v11 offset:1024
    ds_read_b64_tr_b16 v[44:45], v12 offset:0
    ds_read_b64_tr_b16 v[46:47], v12 offset:1024
    ds_read_b64_tr_b16 v[48:49], v10 offset:4096
    ds_read_b64_tr_b16 v[50:51], v10 offset:6144
    ds_read_b64_tr_b16 v[52:53], v11 offset:2048
    ds_read_b64_tr_b16 v[54:55], v11 offset:3072
    ds_read_b64_tr_b16 v[56:57], v12 offset:2048
    ds_read_b64_tr_b16 v[58:59], v12 offset:3072
    ds_read_b64_tr_b16 v[60:61], v10 offset:8192
    ds_read_b64_tr_b16 v[62:63], v10 offset:10240
    ds_read_b64_tr_b16 v[64:65], v11 offset:4096
    ds_read_b64_tr_b16 v[66:67], v11 offset:5120
    ds_read_b64_tr_b16 v[68:69], v12 offset:4096
    ds_read_b64_tr_b16 v[70:71], v12 offset:5120
    s_waitcnt lgkmcnt(12)
    v_mfma_f32_16x16x32_bf16 v[24:27], v[36:39], v[40:43], v[24:27]
    v_mfma_f32_16x16x32_bf16 v[28:31], v[36:39], v[44:47], v[28:31]
    v_mfma_f32_16x16x32_bf16 v[32:35], v[36:39], v[20:23], v[32:35]
    v_mul_f32 v104, s34, v104
    v_mul_f32 v108, s34, v108
    v_mul_f32 v105, s34, v105
    v_mul_f32 v109, s34, v109
    v_mul_f32 v106, s34, v106
    v_mul_f32 v110, s34, v110
    v_mul_f32 v107, s34, v107
    v_mul_f32 v111, s34, v111
    v_mul_f32 v120, s34, v120
    v_mul_f32 v124, s34, v124
    v_mul_f32 v121, s34, v121
    v_mul_f32 v125, s34, v125
    ds_read_b64_tr_b16 v[36:37], v10 offset:12288
    ds_read_b64_tr_b16 v[38:39], v10 offset:14336
    ds_read_b64_tr_b16 v[40:41], v11 offset:6144
    ds_read_b64_tr_b16 v[42:43], v11 offset:7168
    ds_read_b64_tr_b16 v[44:45], v12 offset:6144
    ds_read_b64_tr_b16 v[46:47], v12 offset:7168
    s_waitcnt lgkmcnt(12)
    v_mfma_f32_16x16x32_bf16 v[24:27], v[48:51], v[52:55], v[24:27]
    v_mfma_f32_16x16x32_bf16 v[28:31], v[48:51], v[56:59], v[28:31]
    v_mfma_f32_16x16x32_bf16 v[32:35], v[48:51], v[20:23], v[32:35]
    v_mul_f32 v122, s34, v122
    v_mul_f32 v126, s34, v126
    v_mul_f32 v123, s34, v123
    v_exp_f32 v104, v104
    v_mul_f32 v127, s34, v127
    v_exp_f32 v105, v105
    v_exp_f32 v108, v108
    v_exp_f32 v106, v106
    v_exp_f32 v109, v109
    v_exp_f32 v107, v107
    v_exp_f32 v110, v110
    v_exp_f32 v120, v120
    ds_read_b64_tr_b16 v[48:49], v10 offset:16384
    ds_read_b64_tr_b16 v[50:51], v10 offset:18432
    ds_read_b64_tr_b16 v[52:53], v11 offset:8192
    ds_read_b64_tr_b16 v[54:55], v11 offset:9216
    ds_read_b64_tr_b16 v[56:57], v12 offset:8192
    ds_read_b64_tr_b16 v[58:59], v12 offset:9216
    s_waitcnt lgkmcnt(12)
    v_mfma_f32_16x16x32_bf16 v[24:27], v[60:63], v[64:67], v[24:27]
    v_mfma_f32_16x16x32_bf16 v[28:31], v[60:63], v[68:71], v[28:31]
    v_mfma_f32_16x16x32_bf16 v[32:35], v[60:63], v[20:23], v[32:35]
    v_exp_f32 v111, v111
    v_exp_f32 v121, v121
    v_exp_f32 v124, v124
    v_exp_f32 v122, v122
    v_exp_f32 v125, v125
    v_exp_f32 v123, v123
    v_add_f32 v104, 1.0, v104
    v_add_f32 v105, 1.0, v105
    v_add_f32 v106, 1.0, v106
    v_exp_f32 v126, v126
    v_add_f32 v107, 1.0, v107
    v_add_f32 v120, 1.0, v120
    ds_read_b64_tr_b16 v[60:61], v10 offset:20480
    ds_read_b64_tr_b16 v[62:63], v10 offset:22528
    ds_read_b64_tr_b16 v[64:65], v11 offset:10240
    ds_read_b64_tr_b16 v[66:67], v11 offset:11264
    ds_read_b64_tr_b16 v[68:69], v12 offset:10240
    ds_read_b64_tr_b16 v[70:71], v12 offset:11264
    s_waitcnt lgkmcnt(12)
    v_mfma_f32_16x16x32_bf16 v[24:27], v[36:39], v[40:43], v[24:27]
    v_mfma_f32_16x16x32_bf16 v[28:31], v[36:39], v[44:47], v[28:31]
    v_mfma_f32_16x16x32_bf16 v[32:35], v[36:39], v[20:23], v[32:35]
    v_add_f32 v121, 1.0, v121
    v_exp_f32 v127, v127
    v_add_f32 v122, 1.0, v122
    v_add_f32 v108, 1.0, v108
    v_add_f32 v123, 1.0, v123
    v_rcp_f32 v104, v104
    v_add_f32 v109, 1.0, v109
    v_add_f32 v110, 1.0, v110
    v_add_f32 v111, 1.0, v111
    v_rcp_f32 v105, v105
    v_add_f32 v124, 1.0, v124
    v_add_f32 v125, 1.0, v125
    ds_read_b64_tr_b16 v[36:37], v10 offset:24576
    ds_read_b64_tr_b16 v[38:39], v10 offset:26624
    ds_read_b64_tr_b16 v[40:41], v11 offset:12288
    ds_read_b64_tr_b16 v[42:43], v11 offset:13312
    ds_read_b64_tr_b16 v[44:45], v12 offset:12288
    ds_read_b64_tr_b16 v[46:47], v12 offset:13312
    s_waitcnt lgkmcnt(12)
    v_mfma_f32_16x16x32_bf16 v[24:27], v[48:51], v[52:55], v[24:27]
    v_mfma_f32_16x16x32_bf16 v[28:31], v[48:51], v[56:59], v[28:31]
    v_mfma_f32_16x16x32_bf16 v[32:35], v[48:51], v[20:23], v[32:35]
    v_add_f32 v126, 1.0, v126
    v_rcp_f32 v106, v106
    v_add_f32 v127, 1.0, v127
    v_rcp_f32 v107, v107
    v_rcp_f32 v108, v108
    v_rcp_f32 v120, v120
    v_rcp_f32 v109, v109
    v_rcp_f32 v121, v121
    v_rcp_f32 v110, v110
    v_rcp_f32 v122, v122
    v_rcp_f32 v111, v111
    v_rcp_f32 v123, v123
    ds_read_b64_tr_b16 v[48:49], v10 offset:28672
    ds_read_b64_tr_b16 v[50:51], v10 offset:30720
    ds_read_b64_tr_b16 v[52:53], v11 offset:14336
    ds_read_b64_tr_b16 v[54:55], v11 offset:15360
    ds_read_b64_tr_b16 v[56:57], v12 offset:14336
    ds_read_b64_tr_b16 v[58:59], v12 offset:15360
    s_waitcnt lgkmcnt(12)
    v_mfma_f32_16x16x32_bf16 v[24:27], v[60:63], v[64:67], v[24:27]
    v_mfma_f32_16x16x32_bf16 v[28:31], v[60:63], v[68:71], v[28:31]
    v_mfma_f32_16x16x32_bf16 v[32:35], v[60:63], v[20:23], v[32:35]
    v_mul_f32 v104, v104, v136
    v_mul_f32 v105, v105, v137
    v_mul_f32 v106, v106, v138
    v_rcp_f32 v124, v124
    v_mul_f32 v107, v107, v139
    v_mul_f32 v120, v120, v152
    v_mul_f32 v121, v121, v153
    v_rcp_f32 v125, v125
    v_mul_f32 v122, v122, v154
    v_mul_f32 v123, v123, v155
    v_cvt_pk_bf16_f32 v80, v104, v105
    v_rcp_f32 v126, v126
    s_waitcnt lgkmcnt(6)
    v_mfma_f32_16x16x32_bf16 v[24:27], v[36:39], v[40:43], v[24:27]
    v_mfma_f32_16x16x32_bf16 v[28:31], v[36:39], v[44:47], v[28:31]
    v_mfma_f32_16x16x32_bf16 v[32:35], v[36:39], v[20:23], v[32:35]
    v_cvt_pk_bf16_f32 v81, v106, v107
    v_cvt_pk_bf16_f32 v82, v120, v121
    v_cvt_pk_bf16_f32 v83, v122, v123
    v_rcp_f32 v127, v127
    buffer_store_dwordx4 v[80:83], v1, s[64:67], s55 offen offset:2048 sc1
    v_mul_f32 v108, v108, v140
    v_mul_f32 v109, v109, v141
    v_mul_f32 v110, v110, v142
    v_mul_f32 v111, v111, v143
    v_mul_f32 v124, v124, v156
    v_mul_f32 v125, v125, v157
    v_mul_f32 v126, v126, v158
    s_waitcnt lgkmcnt(0)
    v_mfma_f32_16x16x32_bf16 v[24:27], v[48:51], v[52:55], v[24:27]
    v_mfma_f32_16x16x32_bf16 v[28:31], v[48:51], v[56:59], v[28:31]
    v_mfma_f32_16x16x32_bf16 v[32:35], v[48:51], v[20:23], v[32:35]
    v_mul_f32 v127, v127, v159
    v_cvt_pk_bf16_f32 v84, v108, v109
    v_cvt_pk_bf16_f32 v85, v110, v111
    v_cvt_pk_bf16_f32 v86, v124, v125
    v_cvt_pk_bf16_f32 v87, v126, v127
    buffer_store_dwordx4 v[84:87], v1, s[64:67], s55 offen offset:3072 sc1
    buffer_atomic_add_f32 v24, v4, s[64:67], s58 offen offset:0
    buffer_atomic_add_f32 v25, v4, s[64:67], s58 offen offset:256
    buffer_atomic_add_f32 v26, v4, s[64:67], s58 offen offset:512
    buffer_atomic_add_f32 v27, v4, s[64:67], s58 offen offset:768
    buffer_atomic_add_f32 v28, v4, s[64:67], s58 offen offset:1024
    buffer_atomic_add_f32 v29, v4, s[64:67], s58 offen offset:1280
    buffer_atomic_add_f32 v30, v4, s[64:67], s58 offen offset:1536
    buffer_atomic_add_f32 v31, v4, s[64:67], s58 offen offset:1792
    s_mov_b32 exec_lo, 0x00010001
    s_mov_b32 exec_hi, 0x00010001
    buffer_atomic_add_f32 v32, v2, s[64:67], s59 offen offset:0
    buffer_atomic_add_f32 v33, v2, s[64:67], s59 offen offset:4
    buffer_atomic_add_f32 v34, v2, s[64:67], s59 offen offset:8
    buffer_atomic_add_f32 v35, v2, s[64:67], s59 offen offset:12
    s_mov_b64 exec, -1
    s_add_u32 s60, s51, 96
    s_lshl_b32 s60, s60, 13
    s_add_u32 s60, s60, s54
    s_lshl_b32 s56, s53, 3
    s_add_u32 s60, s60, s56
    v_mul_f32 v224, s34, v224
    v_mul_f32 v232, s34, v232
    v_mul_f32 v225, s34, v225
    v_mul_f32 v233, s34, v233
    v_mul_f32 v226, s34, v226
    v_mul_f32 v234, s34, v234
    v_mul_f32 v227, s34, v227
    v_mul_f32 v235, s34, v235
    v_mul_f32 v228, s34, v228
    v_mul_f32 v236, s34, v236
    v_mul_f32 v229, s34, v229
    v_mul_f32 v237, s34, v237
    v_mul_f32 v230, s34, v230
    v_mul_f32 v238, s34, v238
    v_mul_f32 v231, s34, v231
    v_exp_f32 v224, v224
    v_mul_f32 v239, s34, v239
    v_exp_f32 v225, v225
    v_exp_f32 v232, v232
    v_exp_f32 v226, v226
    v_exp_f32 v233, v233
    v_exp_f32 v227, v227
    v_exp_f32 v234, v234
    v_exp_f32 v228, v228
    v_exp_f32 v235, v235
    v_exp_f32 v229, v229
    v_exp_f32 v236, v236
    v_exp_f32 v230, v230
    v_exp_f32 v237, v237
    v_exp_f32 v231, v231
    v_add_f32 v224, 1.0, v224
    v_add_f32 v225, 1.0, v225
    v_add_f32 v226, 1.0, v226
    v_exp_f32 v238, v238
    v_add_f32 v227, 1.0, v227
    v_add_f32 v228, 1.0, v228
    v_add_f32 v229, 1.0, v229
    v_exp_f32 v239, v239
    v_add_f32 v230, 1.0, v230
    v_add_f32 v232, 1.0, v232
    v_add_f32 v231, 1.0, v231
    v_rcp_f32 v224, v224
    v_add_f32 v233, 1.0, v233
    v_add_f32 v234, 1.0, v234
    v_add_f32 v235, 1.0, v235
    v_rcp_f32 v225, v225
    v_add_f32 v236, 1.0, v236
    v_add_f32 v237, 1.0, v237
    v_add_f32 v238, 1.0, v238
    v_rcp_f32 v226, v226
    v_add_f32 v239, 1.0, v239
    v_rcp_f32 v227, v227
    v_rcp_f32 v232, v232
    v_rcp_f32 v228, v228
    v_rcp_f32 v233, v233
    v_rcp_f32 v229, v229
    v_rcp_f32 v234, v234
    v_rcp_f32 v230, v230
    v_rcp_f32 v235, v235
    v_rcp_f32 v231, v231
    v_mul_f32 v224, v224, v240
    v_mul_f32 v225, v225, v241
    v_mul_f32 v226, v226, v242
    v_rcp_f32 v236, v236
    v_mul_f32 v227, v227, v243
    v_mul_f32 v228, v228, v244
    v_mul_f32 v229, v229, v245
    v_rcp_f32 v237, v237
    v_mul_f32 v230, v230, v246
    v_mul_f32 v231, v231, v247
    v_cvt_pk_bf16_f32 v40, v224, v225
    v_rcp_f32 v238, v238
    v_cvt_pk_bf16_f32 v41, v226, v227
    v_cvt_pk_bf16_f32 v42, v228, v229
    v_cvt_pk_bf16_f32 v43, v230, v231
    v_rcp_f32 v239, v239
    v_mul_f32 v232, v232, v248
    v_mul_f32 v233, v233, v249
    v_mul_f32 v234, v234, v250
    v_mul_f32 v235, v235, v251
    v_mul_f32 v236, v236, v252
    v_mul_f32 v237, v237, v253
    v_mul_f32 v238, v238, v254
    v_mul_f32 v239, v239, v255
    v_cvt_pk_bf16_f32 v44, v232, v233
    v_cvt_pk_bf16_f32 v45, v234, v235
    v_cvt_pk_bf16_f32 v46, v236, v237
    v_cvt_pk_bf16_f32 v47, v238, v239
    buffer_store_dwordx2 v[40:41], v1, s[64:67], s60 offen offset:0 sc1
    buffer_store_dwordx2 v[42:43], v1, s[64:67], s60 offen offset:1024 sc1
    buffer_store_dwordx2 v[44:45], v1, s[64:67], s60 offen offset:2048 sc1
    buffer_store_dwordx2 v[46:47], v1, s[64:67], s60 offen offset:3072 sc1
G1_end:
    s_waitcnt vmcnt(0)
    s_cmp_lg_u32 s3, 0
    s_cbranch_scc1 G1_x1
    v_mov_b32 v2, s79
    v_mov_b32 v3, 147456
    v_mov_b32 v4, 0
    ds_write_b32 v3, v2 offset:4
    ds_write_b32 v3, v4
G1_x1:
    s_waitcnt lgkmcnt(0)
    s_barrier
    v_mov_b32 v3, 147460
    ds_read_b32 v14, v3
    s_cmp_lg_u32 s3, 0
    s_cbranch_scc1 G1_x2
    s_lshl_b32 s55, s47, 5
    s_lshl_b32 s56, s50, 4
    s_add_u32 s55, s55, s56
    s_add_u32 s55, s55, s51
    s_lshl_b32 s55, s55, 6
    s_add_u32 s55, s55, 58818560
    v_mov_b32 v4, 0
    s_mov_b64 exec, 1
    buffer_store_dword v2, v4, s[64:67], s55 offen sc1
    s_mov_b64 exec, -1
G1_x2:
    s_load_dwordx2 s[60:61], s[0:1], 0
    s_load_dwordx2 s[62:63], s[0:1], 24
    s_load_dwordx4 s[64:67], s[0:1], 56
    s_load_dwordx2 s[70:71], s[0:1], 80
    v_mov_b32 v1, v15
    s_mov_b32 s44, s50
    s_and_b32 s40, s2, 7
    s_lshr_b32 s41, s2, 3
    s_and_b32 s41, s41, 7
    s_lshr_b32 s45, s2, 7
    s_lshl_b32 s45, s45, 3
    s_add_u32 s41, s41, s45
    s_lshr_b32 s42, s40, 1
    s_lshl_b32 s42, s42, 2
    s_and_b32 s43, s41, 3
    s_add_u32 s42, s42, s43
    s_and_b32 s43, s40, 1
    s_lshl_b32 s43, s43, 2
    s_lshr_b32 s45, s41, 2
    s_add_u32 s43, s43, s45
    s_lshl_b32 s43, s43, 1
    s_add_u32 s43, s43, s44
    s_cmp_eq_u32 s44, 0
    s_cselect_b32 s72, 32, 24
    s_sub_u32 s73, s72, 3
    s_add_u32 s74, s72, 8
    v_lshlrev_b32 v10, 4, v1
    s_waitcnt lgkmcnt(0)
    s_mov_b32 s16, s70
    s_and_b32 s17, s71, 0xffff
    s_mov_b32 s18, 268435456
    s_mov_b32 s19, 0x20000
    s_lshr_b32 s56, s2, 5
    s_lshl_b32 s57, s56, 5
    s_and_b32 s55, s2, 31
    s_lshr_b32 s58, s55, 1
    s_add_u32 s57, s57, s58
    s_lshl_b32 s57, s57, 6
    s_add_u32 s57, s57, 58818560
    s_lshl_b32 s55, s55, 17
    s_lshl_b32 s56, s56, 14
    s_add_u32 s55, s55, s56
    s_lshl_b32 s56, s3, 11
    s_add_u32 s55, s55, s56
    s_add_u32 s55, s55, 33554432
    s_mov_b32 s68, 0x3fb8aa3b
    s_add_u32 s56, s56, 114688
    s_lshl_b32 s58, s3, 11
    s_add_u32 s56, s56, s58
    v_add_u32 v224, s56, v10
    v_mov_b32 v225, 0
    s_cmp_lt_u32 s3, 4
    s_cbranch_scc1 G2_compute
    s_cmp_ge_u32 s3, 6
    s_cbranch_scc1 G2_helper
    v_lshrrev_b32 v16, 3, v1
    v_and_b32 v17, 7, v1
    v_and_b32 v19, 6, v16
    v_xor_b32 v17, v17, v19
    v_lshlrev_b32 v2, 11, v16
    v_lshl_add_u32 v2, v17, 4, v2
    s_sub_u32 s46, s3, 4
    s_lshl_b32 s33, s46, 13
    s_add_u32 s38, s33, 114688
    s_xor_b32 s32, s43, s46
    s_lshl_b32 s32, s32, 7
    s_mul_i32 s48, s44, 4194304
    s_add_u32 s32, s32, s48
    s_sub_u32 s32, s32, 16384
    s_lshl_b32 s47, s43, 7
    s_lshl_b32 s48, s46, 16
    s_add_u32 s47, s47, s48
    s_sub_u32 s47, s47, 16384
    s_mov_b32 s34, 0
    s_lshr_b32 s53, s42, 1
    s_lshl_b32 s53, s53, 12
    s_add_u32 s53, s53, 58720256
    v_lshlrev_b32 v13, 6, v1
    v_mov_b32 v15, 0
    s_sub_u32 s75, s72, 5
    s_sub_u32 s76, s73, 7
    s_sub_u32 s77, s73, 1
    s_sub_u32 s49, s74, 5
    s_mov_b32 s8, s64
    s_and_b32 s9, s65, 0xffff
    s_mov_b32 s10, 7340032
    s_mov_b32 s11, 0x20000
    s_mov_b32 s36, 8
G2_ldp:
    s_add_u32 m0, s33, 0
    s_add_u32 s32, s32, 16384
    buffer_load_dwordx4 v2, s[8:11], s32 offen lds
    s_add_u32 m0, s33, 1024
    s_add_u32 s32, s32, 16384
    buffer_load_dwordx4 v2, s[8:11], s32 offen lds
    s_add_u32 m0, s33, 2048
    s_add_u32 s32, s32, 16384
    buffer_load_dwordx4 v2, s[8:11], s32 offen lds
    s_add_u32 m0, s33, 3072
    s_add_u32 s32, s32, 16384
    buffer_load_dwordx4 v2, s[8:11], s32 offen lds
    s_add_u32 s32, s32, s34
    s_add_u32 m0, s33, 4096
    s_add_u32 s32, s32, 16384
    buffer_load_dwordx4 v2, s[8:11], s32 offen lds
    s_add_u32 m0, s33, 5120
    s_add_u32 s32, s32, 16384
    buffer_load_dwordx4 v2, s[8:11], s32 offen lds
    s_add_u32 m0, s33, 6144
    s_add_u32 s32, s32, 16384
    buffer_load_dwordx4 v2, s[8:11], s32 offen lds
    s_add_u32 m0, s33, 7168
    s_add_u32 s32, s32, 16384
    buffer_load_dwordx4 v2, s[8:11], s32 offen lds
    s_add_u32 s32, s32, s34
    s_add_u32 s33, s33, 16384
    s_sub_u32 s46, s33, 114688
    s_cmp_ge_u32 s33, s38
    s_cselect_b32 s33, s46, s33
    s_sub_u32 s36, s36, 1
    s_bitcmp1_b32 s36, 0
    s_cbranch_scc1 G2_ldp
    s_cmp_lg_u32 s36, 6
    s_cbranch_scc1 G2_ldq
    s_branch G2_smx
G2_smr1:
G2_ldq:
    s_waitcnt vmcnt(16)
    s_barrier
    s_cmp_lg_u32 s36, 0
    s_cbranch_scc1 G2_ldp
    s_mov_b32 s36, 3
G2_ldl:
    s_cmp_eq_u32 s36, s75
    s_cbranch_scc0 G2_ldn2
    s_mov_b32 s8, s62
    s_and_b32 s9, s63, 0xffff
    s_mov_b32 s10, 2097152
    s_mov_b32 s11, 0x20000
    s_mov_b32 s32, s47
    s_mov_b32 s34, 65536
G2_ldn2:
    s_add_u32 m0, s33, 0
    s_add_u32 s32, s32, 16384
    buffer_load_dwordx4 v2, s[8:11], s32 offen lds
    s_add_u32 m0, s33, 1024
    s_add_u32 s32, s32, 16384
    buffer_load_dwordx4 v2, s[8:11], s32 offen lds
    s_add_u32 m0, s33, 2048
    s_add_u32 s32, s32, 16384
    buffer_load_dwordx4 v2, s[8:11], s32 offen lds
    s_add_u32 m0, s33, 3072
    s_add_u32 s32, s32, 16384
    buffer_load_dwordx4 v2, s[8:11], s32 offen lds
    s_add_u32 s32, s32, s34
    s_add_u32 m0, s33, 4096
    s_add_u32 s32, s32, 16384
    buffer_load_dwordx4 v2, s[8:11], s32 offen lds
    s_add_u32 m0, s33, 5120
    s_add_u32 s32, s32, 16384
    buffer_load_dwordx4 v2, s[8:11], s32 offen lds
    s_add_u32 m0, s33, 6144
    s_add_u32 s32, s32, 16384
    buffer_load_dwordx4 v2, s[8:11], s32 offen lds
    s_add_u32 m0, s33, 7168
    s_add_u32 s32, s32, 16384
    buffer_load_dwordx4 v2, s[8:11], s32 offen lds
    s_add_u32 s32, s32, s34
    s_add_u32 s33, s33, 16384
    s_sub_u32 s46, s33, 114688
    s_cmp_ge_u32 s33, s38
    s_cselect_b32 s33, s46, s33
    s_cmp_lt_u32 s36, s76
    s_cbranch_scc1 G2_ldn3
    s_cmp_ge_u32 s36, s73
    s_cbranch_scc1 G2_ldn3
    s_mov_b32 s52, 0
G2_chk:
    v_cmp_eq_u32 vcc, v14, v15
    s_nop 0
    s_cmp_eq_u64 vcc, -1
    s_cbranch_scc1 G2_ldn3
    buffer_load_dword v15, v13, s[16:19], s53 offen sc1
    s_cmp_lg_u32 s36, s77
    s_cbranch_scc1 G2_ldn3
    s_waitcnt vmcnt(0)
    s_add_u32 s52, s52, 1
    s_cmp_lt_u32 s52, 0x100000
    s_cbranch_scc1 G2_chk
G2_ldn3:
    s_waitcnt vmcnt(32)
    s_barrier
    s_add_u32 s36, s36, 1
    s_cmp_lt_u32 s36, s49
    s_cbranch_scc1 G2_ldl
    s_waitcnt vmcnt(24)
    s_barrier
    s_waitcnt vmcnt(16)
    s_barrier
    s_waitcnt vmcnt(8)
    s_barrier
    s_waitcnt vmcnt(0)
    s_barrier
    s_endpgm
G2_helper:
    v_mov_b32 v3, 147456
    s_and_b32 s48, s2, 31
    s_lshr_b32 s49, s2, 5
    s_sub_u32 s47, s3, 6
    s_mov_b32 s37, 0
    v_lshrrev_b32 v18, 4, v1
    v_lshlrev_b32 v11, 4, v18
    v_mov_b32 v13, 0
    s_lshl_b32 s59, s47, 14
    s_add_u32 s59, s59, 114688
    v_add_u32 v9, s59, v10
    v_lshlrev_b32 v12, 2, v1
    v_add_u32 v12, s59, v12
    s_lshl_b32 s54, s49, 12
    s_lshl_b32 s56, s48, 7
    s_add_u32 s54, s54, s56
    s_lshl_b32 s56, s47, 6
    s_add_u32 s54, s54, s56
    s_add_u32 s54, s54, 58720256
    s_branch G2_smx
G2_smr2:
    s_cmp_lg_u32 s2, 0
    s_cbranch_scc1 G2_ne
    s_cmp_lg_u32 s47, 1
    s_cbranch_scc1 G2_ne
    v_lshlrev_b32 v2, 6, v1
    s_mov_b32 s57, 58785792
    s_mov_b32 s55, 0
G2_ep:
    buffer_load_dword v4, v2, s[16:19], s57 offen sc1
    s_add_u32 s57, s57, 4096
    buffer_load_dword v5, v2, s[16:19], s57 offen sc1
    s_add_u32 s57, s57, 4096
    buffer_load_dword v6, v2, s[16:19], s57 offen sc1
    s_add_u32 s57, s57, 4096
    buffer_load_dword v7, v2, s[16:19], s57 offen sc1
    s_add_u32 s57, s57, 4096
    s_sub_u32 s57, s57, 16384
    s_waitcnt vmcnt(0)
    v_xor_b32 v4, v4, v14
    v_xor_b32 v5, v5, v14
    v_xor_b32 v6, v6, v14
    v_xor_b32 v7, v7, v14
    v_or3_b32 v4, v4, v5, v6
    v_or_b32 v4, v4, v7
    v_cmp_eq_u32 vcc, 0, v4
    s_nop 0
    s_cmp_eq_u64 vcc, -1
    s_cbranch_scc1 G2_eo
    s_add_u32 s55, s55, 1
    s_cmp_lt_u32 s55, 0x100000
    s_cbranch_scc1 G2_ep
G2_eo:
    s_mov_b32 s57, 58802176
    s_mov_b64 exec, 1
    buffer_store_dword v14, v13, s[16:19], s57 offen sc1
    s_mov_b64 exec, -1
G2_ne:
G2_h1:
    s_cmp_ge_u32 s37, 1
    s_cbranch_scc1 G2_h2
    s_barrier
    s_add_u32 s37, s37, 1
    s_branch G2_h1
G2_h2:
    ds_read_b128 v[128:131], v9 offset:0
    ds_read_b128 v[132:135], v9 offset:1024
    ds_read_b128 v[136:139], v9 offset:2048
    ds_read_b128 v[140:143], v9 offset:3072
    ds_read_b128 v[144:147], v9 offset:4096
    ds_read_b128 v[148:151], v9 offset:5120
    ds_read_b128 v[152:155], v9 offset:6144
    ds_read_b128 v[156:159], v9 offset:7168
    ds_read_b128 v[160:163], v9 offset:8192
    ds_read_b128 v[164:167], v9 offset:9216
    ds_read_b128 v[168:171], v9 offset:10240
    ds_read_b128 v[172:175], v9 offset:11264
    ds_read_b128 v[176:179], v9 offset:12288
    ds_read_b128 v[180:183], v9 offset:13312
    ds_read_b128 v[184:187], v9 offset:14336
    ds_read_b128 v[188:191], v9 offset:15360
    s_waitcnt lgkmcnt(0)
    v_and_b32 v2, 7, v1
    v_lshlrev_b32 v2, 11, v2
    s_lshr_b32 s57, s48, 1
    s_add_u32 s57, s57, 16
    s_lshl_b32 s57, s57, 6
    s_add_u32 s57, s57, 58818560
    s_mov_b32 s52, 0
G2_in2:
    buffer_load_dword v15, v2, s[16:19], s57 offen sc1
G2_h3:
    s_getreg_b32 s51, hwreg(HW_REG_IB_STS)
    s_and_b32 s51, s51, 0x00c0000f
    s_cbranch_scc0 G2_h4
    s_cmp_ge_u32 s37, s73
    s_cbranch_scc1 G2_h4
    ds_read_b32 v8, v3
    s_waitcnt lgkmcnt(0)
    v_readfirstlane_b32 s46, v8
    s_nop 0
    s_cmp_le_u32 s46, s37
    s_cbranch_scc1 G2_h5
    s_cmp_ge_u32 s37, s73
    s_cbranch_scc1 G2_h5
    s_barrier
    s_add_u32 s37, s37, 1
G2_h5:
    s_branch G2_h3
G2_h4:
    s_waitcnt vmcnt(0)
    v_cmp_eq_u32 vcc, v14, v15
    s_nop 0
    s_cmp_eq_u64 vcc, -1
    s_cbranch_scc1 G2_in2ok
    ds_read_b32 v8, v3
    s_waitcnt lgkmcnt(0)
    v_readfirstlane_b32 s46, v8
    s_nop 0
    s_cmp_le_u32 s46, s37
    s_cbranch_scc1 G2_h6
    s_cmp_ge_u32 s37, s73
    s_cbranch_scc1 G2_h6
    s_barrier
    s_add_u32 s37, s37, 1
G2_h6:
    s_add_u32 s52, s52, 1
    s_cmp_lt_u32 s52, 0x100000
    s_cbranch_scc1 G2_in2
G2_in2ok:
    s_mul_i32 s50, s48, 9216
    s_add_u32 s50, s50, 50331648
    s_add_u32 s52, s50, 8192
    s_add_u32 m0, s59, 0
    s_add_u32 s51, s50, 0
    buffer_load_dwordx4 v10, s[16:19], s51 offen sc1 lds
    s_add_u32 m0, s59, 1024
    s_add_u32 s51, s50, 1024
    buffer_load_dwordx4 v10, s[16:19], s51 offen sc1 lds
    s_add_u32 m0, s59, 2048
    s_add_u32 s51, s50, 2048
    buffer_load_dwordx4 v10, s[16:19], s51 offen sc1 lds
    s_add_u32 m0, s59, 3072
    s_add_u32 s51, s50, 3072
    buffer_load_dwordx4 v10, s[16:19], s51 offen sc1 lds
    s_add_u32 m0, s59, 4096
    s_add_u32 s51, s50, 4096
    buffer_load_dwordx4 v10, s[16:19], s51 offen sc1 lds
    s_add_u32 m0, s59, 5120
    s_add_u32 s51, s50, 5120
    buffer_load_dwordx4 v10, s[16:19], s51 offen sc1 lds
    ds_read_b32 v8, v3
    s_waitcnt lgkmcnt(0)
    v_readfirstlane_b32 s46, v8
    s_nop 0
    s_cmp_le_u32 s46, s37
    s_cbranch_scc1 G2_h7
    s_cmp_ge_u32 s37, s73
    s_cbranch_scc1 G2_h7
    s_barrier
    s_add_u32 s37, s37, 1
G2_h7:
    s_add_u32 m0, s59, 6144
    s_add_u32 s51, s50, 6144
    buffer_load_dwordx4 v10, s[16:19], s51 offen sc1 lds
    s_add_u32 m0, s59, 7168
    s_add_u32 s51, s50, 7168
    buffer_load_dwordx4 v10, s[16:19], s51 offen sc1 lds
    buffer_load_dwordx4 v[56:59], v11, s[16:19], s52 offen offset:0 sc1
    buffer_load_dwordx4 v[60:63], v11, s[16:19], s52 offen offset:64 sc1
    buffer_load_dwordx4 v[64:67], v11, s[16:19], s52 offen offset:128 sc1
    buffer_load_dwordx4 v[68:71], v11, s[16:19], s52 offen offset:192 sc1
    s_lshl_b32 s50, s49, 1
    s_add_u32 s50, s50, s47
    s_mul_i32 s50, s50, 1179648
    s_add_u32 s51, s48, 112
    s_lshl_b32 s51, s51, 13
    s_add_u32 s50, s50, s51
    s_add_u32 s50, s50, 8388608
G2_h8:
    s_getreg_b32 s51, hwreg(HW_REG_IB_STS)
    s_and_b32 s51, s51, 0x00c0000f
    s_cbranch_scc0 G2_h9
    s_cmp_ge_u32 s37, s73
    s_cbranch_scc1 G2_h9
    ds_read_b32 v8, v3
    s_waitcnt lgkmcnt(0)
    v_readfirstlane_b32 s46, v8
    s_nop 0
    s_cmp_le_u32 s46, s37
    s_cbranch_scc1 G2_h10
    s_cmp_ge_u32 s37, s73
    s_cbranch_scc1 G2_h10
    s_barrier
    s_add_u32 s37, s37, 1
G2_h10:
    s_branch G2_h8
G2_h9:
    s_waitcnt vmcnt(0)
    ds_read_b32 v24, v12 offset:0
    ds_read_b32 v25, v12 offset:256
    ds_read_b32 v26, v12 offset:512
    ds_read_b32 v27, v12 offset:768
    ds_read_b32 v28, v12 offset:1024
    ds_read_b32 v29, v12 offset:1280
    ds_read_b32 v30, v12 offset:1536
    ds_read_b32 v31, v12 offset:1792
    ds_read_b32 v32, v12 offset:2048
    ds_read_b32 v33, v12 offset:2304
    ds_read_b32 v34, v12 offset:2560
    ds_read_b32 v35, v12 offset:2816
    ds_read_b32 v36, v12 offset:3072
    ds_read_b32 v37, v12 offset:3328
    ds_read_b32 v38, v12 offset:3584
    ds_read_b32 v39, v12 offset:3840
    ds_read_b32 v40, v12 offset:4096
    ds_read_b32 v41, v12 offset:4352
    ds_read_b32 v42, v12 offset:4608
    ds_read_b32 v43, v12 offset:4864
    ds_read_b32 v44, v12 offset:5120
    ds_read_b32 v45, v12 offset:5376
    ds_read_b32 v46, v12 offset:5632
    ds_read_b32 v47, v12 offset:5888
    ds_read_b32 v48, v12 offset:6144
    ds_read_b32 v49, v12 offset:6400
    ds_read_b32 v50, v12 offset:6656
    ds_read_b32 v51, v12 offset:6912
    ds_read_b32 v52, v12 offset:7168
    ds_read_b32 v53, v12 offset:7424
    ds_read_b32 v54, v12 offset:7680
    ds_read_b32 v55, v12 offset:7936
    s_waitcnt lgkmcnt(0)
    v_cvt_pk_bf16_f32 v72, v24, v25
    v_cvt_pk_bf16_f32 v73, v26, v27
    v_cvt_pk_bf16_f32 v74, v32, v33
    v_cvt_pk_bf16_f32 v75, v34, v35
    v_cvt_pk_bf16_f32 v76, v28, v29
    v_cvt_pk_bf16_f32 v77, v30, v31
    v_cvt_pk_bf16_f32 v78, v36, v37
    v_cvt_pk_bf16_f32 v79, v38, v39
    v_cvt_pk_bf16_f32 v80, v56, v57
    v_cvt_pk_bf16_f32 v81, v58, v59
    v_cvt_pk_bf16_f32 v82, v60, v61
    v_cvt_pk_bf16_f32 v83, v62, v63
    v_cvt_pk_bf16_f32 v84, v40, v41
    v_cvt_pk_bf16_f32 v85, v42, v43
    v_cvt_pk_bf16_f32 v86, v48, v49
    v_cvt_pk_bf16_f32 v87, v50, v51
    v_cvt_pk_bf16_f32 v88, v44, v45
    v_cvt_pk_bf16_f32 v89, v46, v47
    v_cvt_pk_bf16_f32 v90, v52, v53
    v_cvt_pk_bf16_f32 v91, v54, v55
    v_cvt_pk_bf16_f32 v92, v64, v65
    v_cvt_pk_bf16_f32 v93, v66, v67
    v_cvt_pk_bf16_f32 v94, v68, v69
    v_cvt_pk_bf16_f32 v95, v70, v71
    ds_read_b32 v8, v3
    s_waitcnt lgkmcnt(0)
    v_readfirstlane_b32 s46, v8
    s_nop 0
    s_cmp_le_u32 s46, s37
    s_cbranch_scc1 G2_h11
    s_cmp_ge_u32 s37, s73
    s_cbranch_scc1 G2_h11
    s_barrier
    s_add_u32 s37, s37, 1
G2_h11:
    v_mfma_f32_16x16x32_bf16 v[192:195], v[72:75], v[128:131], 0
    v_mfma_f32_16x16x32_bf16 v[196:199], v[76:79], v[128:131], 0
    v_mfma_f32_16x16x32_bf16 v[200:203], v[80:83], v[128:131], 0
    v_mfma_f32_16x16x32_bf16 v[192:195], v[84:87], v[132:135], v[192:195]
    v_mfma_f32_16x16x32_bf16 v[196:199], v[88:91], v[132:135], v[196:199]
    v_mfma_f32_16x16x32_bf16 v[200:203], v[92:95], v[132:135], v[200:203]
    v_mfma_f32_16x16x32_bf16 v[204:207], v[72:75], v[136:139], 0
    v_mfma_f32_16x16x32_bf16 v[208:211], v[76:79], v[136:139], 0
    v_mfma_f32_16x16x32_bf16 v[212:215], v[80:83], v[136:139], 0
    v_mfma_f32_16x16x32_bf16 v[204:207], v[84:87], v[140:143], v[204:207]
    v_mfma_f32_16x16x32_bf16 v[208:211], v[88:91], v[140:143], v[208:211]
    v_mfma_f32_16x16x32_bf16 v[212:215], v[92:95], v[140:143], v[212:215]
    v_mfma_f32_16x16x32_bf16 v[216:219], v[72:75], v[144:147], 0
    v_mfma_f32_16x16x32_bf16 v[220:223], v[76:79], v[144:147], 0
    v_mfma_f32_16x16x32_bf16 v[224:227], v[80:83], v[144:147], 0
    v_mfma_f32_16x16x32_bf16 v[216:219], v[84:87], v[148:151], v[216:219]
    v_mfma_f32_16x16x32_bf16 v[220:223], v[88:91], v[148:151], v[220:223]
    v_mfma_f32_16x16x32_bf16 v[224:227], v[92:95], v[148:151], v[224:227]
    v_mfma_f32_16x16x32_bf16 v[228:231], v[72:75], v[152:155], 0
    v_mfma_f32_16x16x32_bf16 v[232:235], v[76:79], v[152:155], 0
    v_mfma_f32_16x16x32_bf16 v[236:239], v[80:83], v[152:155], 0
    v_mfma_f32_16x16x32_bf16 v[228:231], v[84:87], v[156:159], v[228:231]
    v_mfma_f32_16x16x32_bf16 v[232:235], v[88:91], v[156:159], v[232:235]
    v_mfma_f32_16x16x32_bf16 v[236:239], v[92:95], v[156:159], v[236:239]
    v_add_f32 v200, 0x358637bd, v200
    v_rcp_f32 v201, v200
    s_nop 0
    v_mul_f32 v192, v192, v201
    v_mul_f32 v193, v193, v201
    v_mul_f32 v194, v194, v201
    v_mul_f32 v195, v195, v201
    v_mul_f32 v196, v196, v201
    v_mul_f32 v197, v197, v201
    v_mul_f32 v198, v198, v201
    v_mul_f32 v199, v199, v201
    v_cvt_pk_bf16_f32 v24, v192, v193
    v_cvt_pk_bf16_f32 v25, v194, v195
    v_cvt_pk_bf16_f32 v26, v196, v197
    v_cvt_pk_bf16_f32 v27, v198, v199
    buffer_store_dwordx4 v[24:27], v10, s[16:19], s50 offen offset:0 sc1
    v_add_f32 v212, 0x358637bd, v212
    v_rcp_f32 v213, v212
    s_nop 0
    v_mul_f32 v204, v204, v213
    v_mul_f32 v205, v205, v213
    v_mul_f32 v206, v206, v213
    v_mul_f32 v207, v207, v213
    v_mul_f32 v208, v208, v213
    v_mul_f32 v209, v209, v213
    v_mul_f32 v210, v210, v213
    v_mul_f32 v211, v211, v213
    v_cvt_pk_bf16_f32 v28, v204, v205
    v_cvt_pk_bf16_f32 v29, v206, v207
    v_cvt_pk_bf16_f32 v30, v208, v209
    v_cvt_pk_bf16_f32 v31, v210, v211
    buffer_store_dwordx4 v[28:31], v10, s[16:19], s50 offen offset:1024 sc1
    ds_read_b32 v8, v3
    s_waitcnt lgkmcnt(0)
    v_readfirstlane_b32 s46, v8
    s_nop 0
    s_cmp_le_u32 s46, s37
    s_cbranch_scc1 G2_h12
    s_cmp_ge_u32 s37, s73
    s_cbranch_scc1 G2_h12
    s_barrier
    s_add_u32 s37, s37, 1
G2_h12:
    s_nop 7
    v_add_f32 v224, 0x358637bd, v224
    v_rcp_f32 v225, v224
    s_nop 0
    v_mul_f32 v216, v216, v225
    v_mul_f32 v217, v217, v225
    v_mul_f32 v218, v218, v225
    v_mul_f32 v219, v219, v225
    v_mul_f32 v220, v220, v225
    v_mul_f32 v221, v221, v225
    v_mul_f32 v222, v222, v225
    v_mul_f32 v223, v223, v225
    v_cvt_pk_bf16_f32 v32, v216, v217
    v_cvt_pk_bf16_f32 v33, v218, v219
    v_cvt_pk_bf16_f32 v34, v220, v221
    v_cvt_pk_bf16_f32 v35, v222, v223
    buffer_store_dwordx4 v[32:35], v10, s[16:19], s50 offen offset:2048 sc1
    v_add_f32 v236, 0x358637bd, v236
    v_rcp_f32 v237, v236
    s_nop 0
    v_mul_f32 v228, v228, v237
    v_mul_f32 v229, v229, v237
    v_mul_f32 v230, v230, v237
    v_mul_f32 v231, v231, v237
    v_mul_f32 v232, v232, v237
    v_mul_f32 v233, v233, v237
    v_mul_f32 v234, v234, v237
    v_mul_f32 v235, v235, v237
    v_cvt_pk_bf16_f32 v36, v228, v229
    v_cvt_pk_bf16_f32 v37, v230, v231
    v_cvt_pk_bf16_f32 v38, v232, v233
    v_cvt_pk_bf16_f32 v39, v234, v235
    buffer_store_dwordx4 v[36:39], v10, s[16:19], s50 offen offset:3072 sc1
    s_add_u32 s50, s50, 4096
    ds_read_b32 v8, v3
    s_waitcnt lgkmcnt(0)
    v_readfirstlane_b32 s46, v8
    s_nop 0
    s_cmp_le_u32 s46, s37
    s_cbranch_scc1 G2_h13
    s_cmp_ge_u32 s37, s73
    s_cbranch_scc1 G2_h13
    s_barrier
    s_add_u32 s37, s37, 1
G2_h13:
    v_mfma_f32_16x16x32_bf16 v[192:195], v[72:75], v[160:163], 0
    v_mfma_f32_16x16x32_bf16 v[196:199], v[76:79], v[160:163], 0
    v_mfma_f32_16x16x32_bf16 v[200:203], v[80:83], v[160:163], 0
    v_mfma_f32_16x16x32_bf16 v[192:195], v[84:87], v[164:167], v[192:195]
    v_mfma_f32_16x16x32_bf16 v[196:199], v[88:91], v[164:167], v[196:199]
    v_mfma_f32_16x16x32_bf16 v[200:203], v[92:95], v[164:167], v[200:203]
    v_mfma_f32_16x16x32_bf16 v[204:207], v[72:75], v[168:171], 0
    v_mfma_f32_16x16x32_bf16 v[208:211], v[76:79], v[168:171], 0
    v_mfma_f32_16x16x32_bf16 v[212:215], v[80:83], v[168:171], 0
    v_mfma_f32_16x16x32_bf16 v[204:207], v[84:87], v[172:175], v[204:207]
    v_mfma_f32_16x16x32_bf16 v[208:211], v[88:91], v[172:175], v[208:211]
    v_mfma_f32_16x16x32_bf16 v[212:215], v[92:95], v[172:175], v[212:215]
    v_mfma_f32_16x16x32_bf16 v[216:219], v[72:75], v[176:179], 0
    v_mfma_f32_16x16x32_bf16 v[220:223], v[76:79], v[176:179], 0
    v_mfma_f32_16x16x32_bf16 v[224:227], v[80:83], v[176:179], 0
    v_mfma_f32_16x16x32_bf16 v[216:219], v[84:87], v[180:183], v[216:219]
    v_mfma_f32_16x16x32_bf16 v[220:223], v[88:91], v[180:183], v[220:223]
    v_mfma_f32_16x16x32_bf16 v[224:227], v[92:95], v[180:183], v[224:227]
    v_mfma_f32_16x16x32_bf16 v[228:231], v[72:75], v[184:187], 0
    v_mfma_f32_16x16x32_bf16 v[232:235], v[76:79], v[184:187], 0
    v_mfma_f32_16x16x32_bf16 v[236:239], v[80:83], v[184:187], 0
    v_mfma_f32_16x16x32_bf16 v[228:231], v[84:87], v[188:191], v[228:231]
    v_mfma_f32_16x16x32_bf16 v[232:235], v[88:91], v[188:191], v[232:235]
    v_mfma_f32_16x16x32_bf16 v[236:239], v[92:95], v[188:191], v[236:239]
    v_add_f32 v200, 0x358637bd, v200
    v_rcp_f32 v201, v200
    s_nop 0
    v_mul_f32 v192, v192, v201
    v_mul_f32 v193, v193, v201
    v_mul_f32 v194, v194, v201
    v_mul_f32 v195, v195, v201
    v_mul_f32 v196, v196, v201
    v_mul_f32 v197, v197, v201
    v_mul_f32 v198, v198, v201
    v_mul_f32 v199, v199, v201
    v_cvt_pk_bf16_f32 v40, v192, v193
    v_cvt_pk_bf16_f32 v41, v194, v195
    v_cvt_pk_bf16_f32 v42, v196, v197
    v_cvt_pk_bf16_f32 v43, v198, v199
    buffer_store_dwordx4 v[40:43], v10, s[16:19], s50 offen offset:0 sc1
    v_add_f32 v212, 0x358637bd, v212
    v_rcp_f32 v213, v212
    s_nop 0
    v_mul_f32 v204, v204, v213
    v_mul_f32 v205, v205, v213
    v_mul_f32 v206, v206, v213
    v_mul_f32 v207, v207, v213
    v_mul_f32 v208, v208, v213
    v_mul_f32 v209, v209, v213
    v_mul_f32 v210, v210, v213
    v_mul_f32 v211, v211, v213
    v_cvt_pk_bf16_f32 v44, v204, v205
    v_cvt_pk_bf16_f32 v45, v206, v207
    v_cvt_pk_bf16_f32 v46, v208, v209
    v_cvt_pk_bf16_f32 v47, v210, v211
    buffer_store_dwordx4 v[44:47], v10, s[16:19], s50 offen offset:1024 sc1
    ds_read_b32 v8, v3
    s_waitcnt lgkmcnt(0)
    v_readfirstlane_b32 s46, v8
    s_nop 0
    s_cmp_le_u32 s46, s37
    s_cbranch_scc1 G2_h14
    s_cmp_ge_u32 s37, s73
    s_cbranch_scc1 G2_h14
    s_barrier
    s_add_u32 s37, s37, 1
G2_h14:
    s_nop 7
    v_add_f32 v224, 0x358637bd, v224
    v_rcp_f32 v225, v224
    s_nop 0
    v_mul_f32 v216, v216, v225
    v_mul_f32 v217, v217, v225
    v_mul_f32 v218, v218, v225
    v_mul_f32 v219, v219, v225
    v_mul_f32 v220, v220, v225
    v_mul_f32 v221, v221, v225
    v_mul_f32 v222, v222, v225
    v_mul_f32 v223, v223, v225
    v_cvt_pk_bf16_f32 v48, v216, v217
    v_cvt_pk_bf16_f32 v49, v218, v219
    v_cvt_pk_bf16_f32 v50, v220, v221
    v_cvt_pk_bf16_f32 v51, v222, v223
    buffer_store_dwordx4 v[48:51], v10, s[16:19], s50 offen offset:2048 sc1
    v_add_f32 v236, 0x358637bd, v236
    v_rcp_f32 v237, v236
    s_nop 0
    v_mul_f32 v228, v228, v237
    v_mul_f32 v229, v229, v237
    v_mul_f32 v230, v230, v237
    v_mul_f32 v231, v231, v237
    v_mul_f32 v232, v232, v237
    v_mul_f32 v233, v233, v237
    v_mul_f32 v234, v234, v237
    v_mul_f32 v235, v235, v237
    v_cvt_pk_bf16_f32 v52, v228, v229
    v_cvt_pk_bf16_f32 v53, v230, v231
    v_cvt_pk_bf16_f32 v54, v232, v233
    v_cvt_pk_bf16_f32 v55, v234, v235
    buffer_store_dwordx4 v[52:55], v10, s[16:19], s50 offen offset:3072 sc1
    s_lshl_b32 s55, s2, 15
    s_lshl_b32 s56, s47, 14
    s_add_u32 s55, s55, s56
    s_add_u32 s55, s55, 83886080
    s_xor_b32 s56, s55, 2097152
    s_lshl_b32 s57, s2, 7
    s_lshl_b32 s58, s47, 6
    s_add_u32 s57, s57, s58
    s_add_u32 s57, s57, 58753024
    s_xor_b32 s58, s57, 8192
    s_add_u32 s53, s72, 2
G2_h15:
    s_getreg_b32 s51, hwreg(HW_REG_IB_STS)
    s_and_b32 s51, s51, 0x00c0000f
    s_cbranch_scc0 G2_h16
    s_cmp_ge_u32 s37, s73
    s_cbranch_scc1 G2_h16
    ds_read_b32 v8, v3
    s_waitcnt lgkmcnt(0)
    v_readfirstlane_b32 s46, v8
    s_nop 0
    s_cmp_le_u32 s46, s37
    s_cbranch_scc1 G2_h17
    s_cmp_ge_u32 s37, s73
    s_cbranch_scc1 G2_h17
    s_barrier
    s_add_u32 s37, s37, 1
G2_h17:
    s_branch G2_h15
G2_h16:
    s_waitcnt vmcnt(0)
    s_mov_b64 exec, 1
    buffer_store_dword v14, v13, s[16:19], s54 offen sc1
    s_mov_b64 exec, -1
G2_h18:
    s_cmp_ge_u32 s37, s53
    s_cbranch_scc1 G2_h19
    s_barrier
    s_add_u32 s37, s37, 1
    s_branch G2_h18
G2_h19:
    ds_read_b128 v[24:27], v9 offset:0
    ds_read_b128 v[28:31], v9 offset:1024
    ds_read_b128 v[32:35], v9 offset:2048
    ds_read_b128 v[36:39], v9 offset:3072
    ds_read_b128 v[40:43], v9 offset:4096
    ds_read_b128 v[44:47], v9 offset:5120
    ds_read_b128 v[48:51], v9 offset:6144
    ds_read_b128 v[52:55], v9 offset:7168
    ds_read_b128 v[56:59], v9 offset:8192
    ds_read_b128 v[60:63], v9 offset:9216
    ds_read_b128 v[64:67], v9 offset:10240
    ds_read_b128 v[68:71], v9 offset:11264
    ds_read_b128 v[72:75], v9 offset:12288
    ds_read_b128 v[76:79], v9 offset:13312
    ds_read_b128 v[80:83], v9 offset:14336
    ds_read_b128 v[84:87], v9 offset:15360
    s_waitcnt lgkmcnt(0)
    buffer_store_dwordx4 v[24:27], v10, s[16:19], s55 offen offset:0 sc1
    buffer_store_dwordx4 v[28:31], v10, s[16:19], s55 offen offset:1024 sc1
    ds_read_b32 v8, v3
    s_waitcnt lgkmcnt(0)
    v_readfirstlane_b32 s46, v8
    s_nop 0
    s_cmp_le_u32 s46, s37
    s_cbranch_scc1 G2_h20
    s_cmp_ge_u32 s37, s74
    s_cbranch_scc1 G2_h20
    s_barrier
    s_add_u32 s37, s37, 1
G2_h20:
    buffer_store_dwordx4 v[32:35], v10, s[16:19], s55 offen offset:2048 sc1
    buffer_store_dwordx4 v[36:39], v10, s[16:19], s55 offen offset:3072 sc1
    s_add_u32 s55, s55, 4096
    ds_read_b32 v8, v3
    s_waitcnt lgkmcnt(0)
    v_readfirstlane_b32 s46, v8
    s_nop 0
    s_cmp_le_u32 s46, s37
    s_cbranch_scc1 G2_h21
    s_cmp_ge_u32 s37, s74
    s_cbranch_scc1 G2_h21
    s_barrier
    s_add_u32 s37, s37, 1
G2_h21:
    buffer_store_dwordx4 v[40:43], v10, s[16:19], s55 offen offset:0 sc1
    buffer_store_dwordx4 v[44:47], v10, s[16:19], s55 offen offset:1024 sc1
    ds_read_b32 v8, v3
    s_waitcnt lgkmcnt(0)
    v_readfirstlane_b32 s46, v8
    s_nop 0
    s_cmp_le_u32 s46, s37
    s_cbranch_scc1 G2_h22
    s_cmp_ge_u32 s37, s74
    s_cbranch_scc1 G2_h22
    s_barrier
    s_add_u32 s37, s37, 1
G2_h22:
    buffer_store_dwordx4 v[48:51], v10, s[16:19], s55 offen offset:2048 sc1
    buffer_store_dwordx4 v[52:55], v10, s[16:19], s55 offen offset:3072 sc1
    s_add_u32 s55, s55, 4096
    ds_read_b32 v8, v3
    s_waitcnt lgkmcnt(0)
    v_readfirstlane_b32 s46, v8
    s_nop 0
    s_cmp_le_u32 s46, s37
    s_cbranch_scc1 G2_h23
    s_cmp_ge_u32 s37, s74
    s_cbranch_scc1 G2_h23
    s_barrier
    s_add_u32 s37, s37, 1
G2_h23:
    buffer_store_dwordx4 v[56:59], v10, s[16:19], s55 offen offset:0 sc1
    buffer_store_dwordx4 v[60:63], v10, s[16:19], s55 offen offset:1024 sc1
    ds_read_b32 v8, v3
    s_waitcnt lgkmcnt(0)
    v_readfirstlane_b32 s46, v8
    s_nop 0
    s_cmp_le_u32 s46, s37
    s_cbranch_scc1 G2_h24
    s_cmp_ge_u32 s37, s74
    s_cbranch_scc1 G2_h24
    s_barrier
    s_add_u32 s37, s37, 1
G2_h24:
    buffer_store_dwordx4 v[64:67], v10, s[16:19], s55 offen offset:2048 sc1
    buffer_store_dwordx4 v[68:71], v10, s[16:19], s55 offen offset:3072 sc1
    s_add_u32 s55, s55, 4096
    ds_read_b32 v8, v3
    s_waitcnt lgkmcnt(0)
    v_readfirstlane_b32 s46, v8
    s_nop 0
    s_cmp_le_u32 s46, s37
    s_cbranch_scc1 G2_h25
    s_cmp_ge_u32 s37, s74
    s_cbranch_scc1 G2_h25
    s_barrier
    s_add_u32 s37, s37, 1
G2_h25:
    buffer_store_dwordx4 v[72:75], v10, s[16:19], s55 offen offset:0 sc1
    buffer_store_dwordx4 v[76:79], v10, s[16:19], s55 offen offset:1024 sc1
    ds_read_b32 v8, v3
    s_waitcnt lgkmcnt(0)
    v_readfirstlane_b32 s46, v8
    s_nop 0
    s_cmp_le_u32 s46, s37
    s_cbranch_scc1 G2_h26
    s_cmp_ge_u32 s37, s74
    s_cbranch_scc1 G2_h26
    s_barrier
    s_add_u32 s37, s37, 1
G2_h26:
    buffer_store_dwordx4 v[80:83], v10, s[16:19], s55 offen offset:2048 sc1
    buffer_store_dwordx4 v[84:87], v10, s[16:19], s55 offen offset:3072 sc1
    s_add_u32 s55, s55, 4096
    ds_read_b32 v8, v3
    s_waitcnt lgkmcnt(0)
    v_readfirstlane_b32 s46, v8
    s_nop 0
    s_cmp_le_u32 s46, s37
    s_cbranch_scc1 G2_h27
    s_cmp_ge_u32 s37, s74
    s_cbranch_scc1 G2_h27
    s_barrier
    s_add_u32 s37, s37, 1
G2_h27:
G2_h28:
    s_getreg_b32 s51, hwreg(HW_REG_IB_STS)
    s_and_b32 s51, s51, 0x00c0000f
    s_cbranch_scc0 G2_h29
    s_cmp_ge_u32 s37, s74
    s_cbranch_scc1 G2_h29
    ds_read_b32 v8, v3
    s_waitcnt lgkmcnt(0)
    v_readfirstlane_b32 s46, v8
    s_nop 0
    s_cmp_le_u32 s46, s37
    s_cbranch_scc1 G2_h30
    s_cmp_ge_u32 s37, s74
    s_cbranch_scc1 G2_h30
    s_barrier
    s_add_u32 s37, s37, 1
G2_h30:
    s_branch G2_h28
G2_h29:
    s_waitcnt vmcnt(0)
    s_mov_b64 exec, 1
    buffer_store_dword v14, v13, s[16:19], s57 offen sc1
    s_mov_b64 exec, -1
    s_mov_b32 s52, 0
G2_chk2:
    buffer_load_dword v15, v13, s[16:19], s58 offen sc1
G2_h31:
    s_getreg_b32 s51, hwreg(HW_REG_IB_STS)
    s_and_b32 s51, s51, 0x00c0000f
    s_cbranch_scc0 G2_h32
    s_cmp_ge_u32 s37, s74
    s_cbranch_scc1 G2_h32
    ds_read_b32 v8, v3
    s_waitcnt lgkmcnt(0)
    v_readfirstlane_b32 s46, v8
    s_nop 0
    s_cmp_le_u32 s46, s37
    s_cbranch_scc1 G2_h33
    s_cmp_ge_u32 s37, s74
    s_cbranch_scc1 G2_h33
    s_barrier
    s_add_u32 s37, s37, 1
G2_h33:
    s_branch G2_h31
G2_h32:
    s_waitcnt vmcnt(0)
    v_cmp_eq_u32 vcc, v14, v15
    s_nop 0
    s_cmp_eq_u64 vcc, -1
    s_cbranch_scc1 G2_ok2
    s_add_u32 s52, s52, 1
    s_cmp_lt_u32 s52, 0x100000
    s_cbranch_scc1 G2_chk2
G2_ok2:
    s_add_u32 m0, s59, 0
    s_add_u32 s51, s56, 0
    buffer_load_dwordx4 v10, s[16:19], s51 offen sc1 lds
    s_add_u32 m0, s59, 1024
    s_add_u32 s51, s56, 1024
    buffer_load_dwordx4 v10, s[16:19], s51 offen sc1 lds
    s_add_u32 m0, s59, 2048
    s_add_u32 s51, s56, 2048
    buffer_load_dwordx4 v10, s[16:19], s51 offen sc1 lds
    s_add_u32 m0, s59, 3072
    s_add_u32 s51, s56, 3072
    buffer_load_dwordx4 v10, s[16:19], s51 offen sc1 lds
    ds_read_b32 v8, v3
    s_waitcnt lgkmcnt(0)
    v_readfirstlane_b32 s46, v8
    s_nop 0
    s_cmp_le_u32 s46, s37
    s_cbranch_scc1 G2_h34
    s_cmp_ge_u32 s37, s74
    s_cbranch_scc1 G2_h34
    s_barrier
    s_add_u32 s37, s37, 1
G2_h34:
    s_add_u32 m0, s59, 4096
    s_add_u32 s51, s56, 4096
    buffer_load_dwordx4 v10, s[16:19], s51 offen sc1 lds
    s_add_u32 m0, s59, 5120
    s_add_u32 s51, s56, 5120
    buffer_load_dwordx4 v10, s[16:19], s51 offen sc1 lds
    s_add_u32 m0, s59, 6144
    s_add_u32 s51, s56, 6144
    buffer_load_dwordx4 v10, s[16:19], s51 offen sc1 lds
    s_add_u32 m0, s59, 7168
    s_add_u32 s51, s56, 7168
    buffer_load_dwordx4 v10, s[16:19], s51 offen sc1 lds
    ds_read_b32 v8, v3
    s_waitcnt lgkmcnt(0)
    v_readfirstlane_b32 s46, v8
    s_nop 0
    s_cmp_le_u32 s46, s37
    s_cbranch_scc1 G2_h35
    s_cmp_ge_u32 s37, s74
    s_cbranch_scc1 G2_h35
    s_barrier
    s_add_u32 s37, s37, 1
G2_h35:
    s_add_u32 m0, s59, 8192
    s_add_u32 s51, s56, 8192
    buffer_load_dwordx4 v10, s[16:19], s51 offen sc1 lds
    s_add_u32 m0, s59, 9216
    s_add_u32 s51, s56, 9216
    buffer_load_dwordx4 v10, s[16:19], s51 offen sc1 lds
    s_add_u32 m0, s59, 10240
    s_add_u32 s51, s56, 10240
    buffer_load_dwordx4 v10, s[16:19], s51 offen sc1 lds
    s_add_u32 m0, s59, 11264
    s_add_u32 s51, s56, 11264
    buffer_load_dwordx4 v10, s[16:19], s51 offen sc1 lds
    ds_read_b32 v8, v3
    s_waitcnt lgkmcnt(0)
    v_readfirstlane_b32 s46, v8
    s_nop 0
    s_cmp_le_u32 s46, s37
    s_cbranch_scc1 G2_h36
    s_cmp_ge_u32 s37, s74
    s_cbranch_scc1 G2_h36
    s_barrier
    s_add_u32 s37, s37, 1
G2_h36:
    s_add_u32 m0, s59, 12288
    s_add_u32 s51, s56, 12288
    buffer_load_dwordx4 v10, s[16:19], s51 offen sc1 lds
    s_add_u32 m0, s59, 13312
    s_add_u32 s51, s56, 13312
    buffer_load_dwordx4 v10, s[16:19], s51 offen sc1 lds
    s_add_u32 m0, s59, 14336
    s_add_u32 s51, s56, 14336
    buffer_load_dwordx4 v10, s[16:19], s51 offen sc1 lds
    s_add_u32 m0, s59, 15360
    s_add_u32 s51, s56, 15360
    buffer_load_dwordx4 v10, s[16:19], s51 offen sc1 lds
    ds_read_b32 v8, v3
    s_waitcnt lgkmcnt(0)
    v_readfirstlane_b32 s46, v8
    s_nop 0
    s_cmp_le_u32 s46, s37
    s_cbranch_scc1 G2_h37
    s_cmp_ge_u32 s37, s74
    s_cbranch_scc1 G2_h37
    s_barrier
    s_add_u32 s37, s37, 1
G2_h37:
G2_h38:
    s_cmp_ge_u32 s37, s74
    s_cbranch_scc1 G2_h39
    s_barrier
    s_add_u32 s37, s37, 1
    s_branch G2_h38
G2_h39:
    s_waitcnt vmcnt(0)
    s_barrier
    s_endpgm
G2_smx:
    s_mov_b32 s52, 0
G2_pwx:
    buffer_load_dword v226, v225, s[16:19], s57 offen sc1
    s_waitcnt vmcnt(0)
    v_cmp_eq_u32 vcc, v14, v226
    s_nop 0
    s_cmp_eq_u64 vcc, -1
    s_cbranch_scc1 G2_pkx
    s_sleep 1
    s_add_u32 s52, s52, 1
    s_cmp_lt_u32 s52, 0x100000
    s_cbranch_scc1 G2_pwx
G2_pkx:
    buffer_load_dwordx4 v[216:219], v10, s[16:19], s55 offen sc1
    buffer_load_dwordx4 v[220:223], v10, s[16:19], s55 offen offset:1024 sc1
    s_waitcnt vmcnt(0)
    v_lshlrev_b32 v92, 16, v216
    v_lshlrev_b32 v124, 16, v220
    v_and_b32 v93, 0xffff0000, v216
    v_and_b32 v125, 0xffff0000, v220
    v_lshlrev_b32 v94, 16, v217
    v_lshlrev_b32 v126, 16, v221
    v_and_b32 v95, 0xffff0000, v217
    v_and_b32 v127, 0xffff0000, v221
    v_lshlrev_b32 v96, 16, v218
    v_lshlrev_b32 v128, 16, v222
    v_and_b32 v97, 0xffff0000, v218
    v_and_b32 v129, 0xffff0000, v222
    v_lshlrev_b32 v98, 16, v219
    v_lshlrev_b32 v130, 16, v223
    v_and_b32 v99, 0xffff0000, v219
    v_and_b32 v131, 0xffff0000, v223
    v_max3_f32 v108, v92, v93, v94
    v_max3_f32 v140, v124, v125, v126
    v_min3_f32 v109, v92, v93, v94
    v_min3_f32 v141, v124, v125, v126
    v_max3_f32 v110, v95, v96, v97
    v_max3_f32 v142, v127, v128, v129
    v_min3_f32 v111, v95, v96, v97
    v_min3_f32 v143, v127, v128, v129
    v_max3_f32 v108, v108, v98, v99
    v_max3_f32 v140, v140, v130, v131
    v_min3_f32 v109, v109, v98, v99
    v_min3_f32 v141, v141, v130, v131
    v_max_f32 v108, v108, v110
    v_max_f32 v140, v140, v142
    v_max_f32 v109, -v109, -v111
    v_max_f32 v141, -v141, -v143
    s_nop 0
    v_permlane16_swap_b32 v108, v109
    v_permlane16_swap_b32 v140, v141
    v_max_f32 v108, v108, v109
    v_max_f32 v140, v140, v141
    v_mov_b32 v109, v108
    v_mov_b32 v141, v140
    s_nop 0
    v_permlane32_swap_b32 v108, v109
    v_permlane32_swap_b32 v140, v141
    v_max_f32 v108, v108, v109
    v_max_f32 v140, v140, v141
    v_mov_b32 v109, v108
    v_mov_b32 v141, v140
    s_nop 0
    v_permlane16_swap_b32 v108, v109
    v_permlane16_swap_b32 v140, v141
    v_mul_f32 v110, s68, v108
    v_mul_f32 v142, s68, v140
    v_mul_f32 v111, s68, v109
    v_mul_f32 v143, s68, v141
    v_fma_f32 v100, -v92, s68, -v111
    v_fma_f32 v132, -v124, s68, -v143
    v_fma_f32 v92, v92, s68, -v110
    v_fma_f32 v124, v124, s68, -v142
    v_fma_f32 v101, -v93, s68, -v111
    v_fma_f32 v133, -v125, s68, -v143
    v_fma_f32 v93, v93, s68, -v110
    v_fma_f32 v125, v125, s68, -v142
    v_fma_f32 v102, -v94, s68, -v111
    v_fma_f32 v134, -v126, s68, -v143
    v_fma_f32 v94, v94, s68, -v110
    v_fma_f32 v126, v126, s68, -v142
    v_fma_f32 v103, -v95, s68, -v111
    v_fma_f32 v135, -v127, s68, -v143
    v_fma_f32 v95, v95, s68, -v110
    v_fma_f32 v127, v127, s68, -v142
    v_fma_f32 v104, -v96, s68, -v111
    v_fma_f32 v136, -v128, s68, -v143
    v_fma_f32 v96, v96, s68, -v110
    v_fma_f32 v128, v128, s68, -v142
    v_fma_f32 v105, -v97, s68, -v111
    v_fma_f32 v137, -v129, s68, -v143
    v_fma_f32 v97, v97, s68, -v110
    v_fma_f32 v129, v129, s68, -v142
    v_fma_f32 v106, -v98, s68, -v111
    v_fma_f32 v138, -v130, s68, -v143
    v_fma_f32 v98, v98, s68, -v110
    v_fma_f32 v130, v130, s68, -v142
    v_fma_f32 v107, -v99, s68, -v111
    v_fma_f32 v139, -v131, s68, -v143
    v_fma_f32 v99, v99, s68, -v110
    v_fma_f32 v131, v131, s68, -v142
    v_exp_f32 v92, v92
    v_exp_f32 v124, v124
    v_exp_f32 v100, v100
    v_exp_f32 v132, v132
    v_exp_f32 v93, v93
    v_exp_f32 v125, v125
    v_exp_f32 v101, v101
    v_exp_f32 v133, v133
    v_exp_f32 v94, v94
    v_exp_f32 v126, v126
    v_exp_f32 v102, v102
    v_exp_f32 v134, v134
    v_exp_f32 v95, v95
    v_exp_f32 v127, v127
    v_exp_f32 v103, v103
    v_exp_f32 v135, v135
    v_exp_f32 v96, v96
    v_exp_f32 v128, v128
    v_exp_f32 v104, v104
    v_exp_f32 v136, v136
    v_exp_f32 v97, v97
    v_exp_f32 v129, v129
    v_exp_f32 v105, v105
    v_exp_f32 v137, v137
    v_exp_f32 v98, v98
    v_exp_f32 v130, v130
    v_exp_f32 v106, v106
    v_exp_f32 v138, v138
    v_exp_f32 v99, v99
    v_exp_f32 v131, v131
    v_exp_f32 v107, v107
    v_exp_f32 v139, v139
    v_add_f32 v108, v92, v93
    v_add_f32 v140, v124, v125
    v_add_f32 v109, v100, v101
    v_add_f32 v141, v132, v133
    v_add_f32 v110, v94, v95
    v_add_f32 v142, v126, v127
    v_add_f32 v111, v102, v103
    v_add_f32 v143, v134, v135
    v_add_f32 v108, v108, v96
    v_add_f32 v140, v140, v128
    v_add_f32 v109, v109, v104
    v_add_f32 v141, v141, v136
    v_add_f32 v110, v110, v97
    v_add_f32 v142, v142, v129
    v_add_f32 v111, v111, v105
    v_add_f32 v143, v143, v137
    v_add_f32 v108, v108, v98
    v_add_f32 v140, v140, v130
    v_add_f32 v109, v109, v106
    v_add_f32 v141, v141, v138
    v_add_f32 v110, v110, v99
    v_add_f32 v142, v142, v131
    v_add_f32 v111, v111, v107
    v_add_f32 v143, v143, v139
    v_add_f32 v108, v108, v110
    v_add_f32 v140, v140, v142
    v_add_f32 v109, v109, v111
    v_add_f32 v141, v141, v143
    s_nop 0
    v_permlane16_swap_b32 v108, v109
    v_permlane16_swap_b32 v140, v141
    v_add_f32 v108, v108, v109
    v_add_f32 v140, v140, v141
    v_mov_b32 v109, v108
    v_mov_b32 v141, v140
    s_nop 0
    v_permlane32_swap_b32 v108, v109
    v_permlane32_swap_b32 v140, v141
    v_add_f32 v108, v108, v109
    v_add_f32 v140, v140, v141
    v_mov_b32 v109, v108
    v_mov_b32 v141, v140
    s_nop 0
    v_permlane16_swap_b32 v108, v109
    v_permlane16_swap_b32 v140, v141
    v_rcp_f32 v108, v108
    v_rcp_f32 v140, v140
    v_rcp_f32 v109, v109
    v_rcp_f32 v141, v141
    v_mul_f32 v92, v92, v108
    v_mul_f32 v124, v124, v140
    v_mul_f32 v100, v100, v109
    v_mul_f32 v132, v132, v141
    v_mul_f32 v93, v93, v108
    v_mul_f32 v125, v125, v140
    v_mul_f32 v101, v101, v109
    v_mul_f32 v133, v133, v141
    v_mul_f32 v94, v94, v108
    v_mul_f32 v126, v126, v140
    v_mul_f32 v102, v102, v109
    v_mul_f32 v134, v134, v141
    v_mul_f32 v95, v95, v108
    v_mul_f32 v127, v127, v140
    v_mul_f32 v103, v103, v109
    v_mul_f32 v135, v135, v141
    v_mul_f32 v96, v96, v108
    v_mul_f32 v128, v128, v140
    v_mul_f32 v104, v104, v109
    v_mul_f32 v136, v136, v141
    v_mul_f32 v97, v97, v108
    v_mul_f32 v129, v129, v140
    v_mul_f32 v105, v105, v109
    v_mul_f32 v137, v137, v141
    v_mul_f32 v98, v98, v108
    v_mul_f32 v130, v130, v140
    v_mul_f32 v106, v106, v109
    v_mul_f32 v138, v138, v141
    v_mul_f32 v99, v99, v108
    v_mul_f32 v131, v131, v140
    v_mul_f32 v107, v107, v109
    v_mul_f32 v139, v139, v141
    v_cvt_pk_bf16_f32 v112, v92, v93
    v_cvt_pk_bf16_f32 v144, v124, v125
    v_cvt_pk_bf16_f32 v116, v100, v101
    v_cvt_pk_bf16_f32 v148, v132, v133
    v_cvt_pk_bf16_f32 v113, v94, v95
    v_cvt_pk_bf16_f32 v145, v126, v127
    v_cvt_pk_bf16_f32 v117, v102, v103
    v_cvt_pk_bf16_f32 v149, v134, v135
    v_cvt_pk_bf16_f32 v114, v96, v97
    v_cvt_pk_bf16_f32 v146, v128, v129
    v_cvt_pk_bf16_f32 v118, v104, v105
    v_cvt_pk_bf16_f32 v150, v136, v137
    v_cvt_pk_bf16_f32 v115, v98, v99
    v_cvt_pk_bf16_f32 v147, v130, v131
    v_cvt_pk_bf16_f32 v119, v106, v107
    v_cvt_pk_bf16_f32 v151, v138, v139
    ds_write_b128 v224, v[112:115] offset:0
    ds_write_b128 v224, v[144:147] offset:2048
    ds_write_b128 v224, v[116:119] offset:1024
    ds_write_b128 v224, v[148:151] offset:3072
    s_waitcnt lgkmcnt(0)
    s_cmp_ge_u32 s3, 6
    s_cbranch_scc1 G2_smr2
    s_branch G2_smr1
G2_compute:
    s_setprio 2
    s_mov_b32 s52, 0
G2_pwc:
    buffer_load_dword v226, v225, s[16:19], s57 offen sc1
    s_waitcnt vmcnt(0)
    v_cmp_eq_u32 vcc, v14, v226
    s_nop 0
    s_cmp_eq_u64 vcc, -1
    s_cbranch_scc1 G2_pkc
    s_sleep 1
    s_add_u32 s52, s52, 1
    s_cmp_lt_u32 s52, 0x100000
    s_cbranch_scc1 G2_pwc
G2_pkc:
    buffer_load_dwordx4 v[216:219], v10, s[16:19], s55 offen sc1
    buffer_load_dwordx4 v[220:223], v10, s[16:19], s55 offen offset:1024 sc1
    s_lshr_b32 s53, s42, 1
    s_lshl_b32 s53, s53, 5
    s_lshl_b32 s56, s44, 4
    s_add_u32 s53, s53, s56
    s_lshl_b32 s53, s53, 6
    s_add_u32 s53, s53, 58818560
    v_and_b32 v16, 15, v1
    v_lshlrev_b32 v17, 6, v16
    buffer_load_dword v19, v17, s[16:19], s53 offen sc1
    s_mul_i32 s50, s42, 1179648
    s_add_u32 s50, s50, 8388608
    s_lshl_b32 s32, s3, 11
    s_mul_i32 s51, s44, 524288
    s_add_u32 s32, s32, s51
    s_sub_u32 s32, s32, 8192
    s_cmp_eq_u32 s44, 0
    s_cselect_b32 s34, 393216, 0
    s_add_u32 s8, s70, s50
    s_addc_u32 s9, s71, 0
    s_and_b32 s9, s9, 0xffff
    s_mov_b32 s10, 1179648
    s_mov_b32 s11, 0x20000
    v_lshrrev_b32 v18, 4, v1
    s_mov_b32 s24, s60
    s_and_b32 s25, s61, 0xffff
    s_mov_b32 s26, 4194304
    s_mov_b32 s27, 0x20000
    s_mov_b32 s28, s66
    s_and_b32 s29, s67, 0xffff
    s_mov_b32 s30, 4194304
    s_mov_b32 s31, 0x20000
    v_and_b32 v21, 1, v18
    v_lshlrev_b32 v21, 5, v21
    v_lshrrev_b32 v20, 1, v18
    v_lshl_add_u32 v21, v20, 4, v21
    v_lshl_add_u32 v11, v16, 11, v21
    s_lshl_b32 s54, s42, 18
    s_lshl_b32 s56, s3, 16
    s_add_u32 s54, s54, s56
    s_lshl_b32 s56, s43, 7
    s_add_u32 s54, s54, s56
    s_add_u32 s57, s54, 32768
    buffer_load_dwordx4 v[232:235], v11, s[24:27], s54 offen offset:0
    buffer_load_dwordx4 v[236:239], v11, s[24:27], s54 offen offset:64
    buffer_load_dwordx4 v[240:243], v11, s[24:27], s57 offen offset:0
    buffer_load_dwordx4 v[244:247], v11, s[24:27], s57 offen offset:64
    v_lshrrev_b32 v12, 2, v1
    v_and_b32 v12, 3, v12
    v_and_b32 v20, 3, v1
    v_lshl_add_u32 v21, v18, 2, v12
    v_and_b32 v22, 6, v21
    v_lshrrev_b32 v23, 1, v20
    v_and_b32 v13, 1, v20
    v_lshlrev_b32 v13, 3, v13
    v_lshl_add_u32 v13, v21, 7, v13
    v_add_u32 v16, 0, v23
    v_xor_b32 v16, v16, v22
    v_lshl_add_u32 v6, v16, 4, v13
    v_mov_b32 v2, v6
    v_add_u32 v16, 2, v23
    v_xor_b32 v16, v16, v22
    v_lshl_add_u32 v7, v16, 4, v13
    v_mov_b32 v3, v7
    v_add_u32 v16, 4, v23
    v_xor_b32 v16, v16, v22
    v_lshl_add_u32 v8, v16, 4, v13
    v_mov_b32 v4, v8
    v_add_u32 v16, 6, v23
    v_xor_b32 v16, v16, v22
    v_lshl_add_u32 v9, v16, 4, v13
    v_mov_b32 v5, v9
    s_lshl_b32 s51, s3, 13
    s_add_u32 s51, s51, 114688
    v_add_u32 v12, s51, v10
    s_mov_b32 s33, 0
    v_mov_b32 v152, 0
    v_mov_b32 v153, 0
    v_mov_b32 v154, 0
    v_mov_b32 v155, 0
    v_mov_b32 v156, 0
    v_mov_b32 v157, 0
    v_mov_b32 v158, 0
    v_mov_b32 v159, 0
    v_mov_b32 v160, 0
    v_mov_b32 v161, 0
    v_mov_b32 v162, 0
    v_mov_b32 v163, 0
    v_mov_b32 v164, 0
    v_mov_b32 v165, 0
    v_mov_b32 v166, 0
    v_mov_b32 v167, 0
    v_mov_b32 v168, 0
    v_mov_b32 v169, 0
    v_mov_b32 v170, 0
    v_mov_b32 v171, 0
    v_mov_b32 v172, 0
    v_mov_b32 v173, 0
    v_mov_b32 v174, 0
    v_mov_b32 v175, 0
    v_mov_b32 v176, 0
    v_mov_b32 v177, 0
    v_mov_b32 v178, 0
    v_mov_b32 v179, 0
    v_mov_b32 v180, 0
    v_mov_b32 v181, 0
    v_mov_b32 v182, 0
    v_mov_b32 v183, 0
    v_mov_b32 v184, 0
    v_mov_b32 v185, 0
    v_mov_b32 v186, 0
    v_mov_b32 v187, 0
    v_mov_b32 v188, 0
    v_mov_b32 v189, 0
    v_mov_b32 v190, 0
    v_mov_b32 v191, 0
    v_mov_b32 v192, 0
    v_mov_b32 v193, 0
    v_mov_b32 v194, 0
    v_mov_b32 v195, 0
    v_mov_b32 v196, 0
    v_mov_b32 v197, 0
    v_mov_b32 v198, 0
    v_mov_b32 v199, 0
    v_mov_b32 v200, 0
    v_mov_b32 v201, 0
    v_mov_b32 v202, 0
    v_mov_b32 v203, 0
    v_mov_b32 v204, 0
    v_mov_b32 v205, 0
    v_mov_b32 v206, 0
    v_mov_b32 v207, 0
    v_mov_b32 v208, 0
    v_mov_b32 v209, 0
    v_mov_b32 v210, 0
    v_mov_b32 v211, 0
    v_mov_b32 v212, 0
    v_mov_b32 v213, 0
    v_mov_b32 v214, 0
    v_mov_b32 v215, 0
    s_waitcnt vmcnt(0)
    v_cmp_eq_u32 vcc, v14, v19
    s_nop 0
    s_cmp_eq_u64 vcc, -1
    s_cselect_b32 s69, 1, 0
    s_cbranch_scc0 G2_hn
G2_xl:
    s_add_u32 s32, s32, 8192
    buffer_load_dwordx4 v[24:27], v10, s[8:11], s32 offen sc1
    buffer_load_dwordx4 v[28:31], v10, s[8:11], s32 offen offset:1024 sc1
    s_add_u32 s32, s32, 8192
    buffer_load_dwordx4 v[32:35], v10, s[8:11], s32 offen sc1
    buffer_load_dwordx4 v[36:39], v10, s[8:11], s32 offen offset:1024 sc1
    s_add_u32 s32, s32, 8192
    buffer_load_dwordx4 v[40:43], v10, s[8:11], s32 offen sc1
    buffer_load_dwordx4 v[44:47], v10, s[8:11], s32 offen offset:1024 sc1
    s_add_u32 s32, s32, 8192
    buffer_load_dwordx4 v[48:51], v10, s[8:11], s32 offen sc1
    buffer_load_dwordx4 v[52:55], v10, s[8:11], s32 offen offset:1024 sc1
    s_add_u32 s32, s32, 8192
    buffer_load_dwordx4 v[56:59], v10, s[8:11], s32 offen sc1
    buffer_load_dwordx4 v[60:63], v10, s[8:11], s32 offen offset:1024 sc1
    s_add_u32 s32, s32, 8192
    buffer_load_dwordx4 v[64:67], v10, s[8:11], s32 offen sc1
    buffer_load_dwordx4 v[68:71], v10, s[8:11], s32 offen offset:1024 sc1
    s_add_u32 s32, s32, 8192
    buffer_load_dwordx4 v[72:75], v10, s[8:11], s32 offen sc1
    buffer_load_dwordx4 v[76:79], v10, s[8:11], s32 offen offset:1024 sc1
    s_cmp_eq_u32 s69, 2
    s_cbranch_scc1 G2_xd
G2_hn:
    v_lshlrev_b32 v92, 16, v216
    v_lshlrev_b32 v124, 16, v220
    v_and_b32 v93, 0xffff0000, v216
    v_and_b32 v125, 0xffff0000, v220
    v_lshlrev_b32 v94, 16, v217
    v_lshlrev_b32 v126, 16, v221
    v_and_b32 v95, 0xffff0000, v217
    v_and_b32 v127, 0xffff0000, v221
    v_lshlrev_b32 v96, 16, v218
    v_lshlrev_b32 v128, 16, v222
    v_and_b32 v97, 0xffff0000, v218
    v_and_b32 v129, 0xffff0000, v222
    v_lshlrev_b32 v98, 16, v219
    v_lshlrev_b32 v130, 16, v223
    v_and_b32 v99, 0xffff0000, v219
    v_and_b32 v131, 0xffff0000, v223
    v_max3_f32 v108, v92, v93, v94
    v_max3_f32 v140, v124, v125, v126
    v_min3_f32 v109, v92, v93, v94
    v_min3_f32 v141, v124, v125, v126
    v_max3_f32 v110, v95, v96, v97
    v_max3_f32 v142, v127, v128, v129
    v_min3_f32 v111, v95, v96, v97
    v_min3_f32 v143, v127, v128, v129
    v_max3_f32 v108, v108, v98, v99
    v_max3_f32 v140, v140, v130, v131
    v_min3_f32 v109, v109, v98, v99
    v_min3_f32 v141, v141, v130, v131
    v_max_f32 v108, v108, v110
    v_max_f32 v140, v140, v142
    v_max_f32 v109, -v109, -v111
    v_max_f32 v141, -v141, -v143
    s_nop 0
    v_permlane16_swap_b32 v108, v109
    v_permlane16_swap_b32 v140, v141
    v_max_f32 v108, v108, v109
    v_max_f32 v140, v140, v141
    v_mov_b32 v109, v108
    v_mov_b32 v141, v140
    s_nop 0
    v_permlane32_swap_b32 v108, v109
    v_permlane32_swap_b32 v140, v141
    v_max_f32 v108, v108, v109
    v_max_f32 v140, v140, v141
    v_mov_b32 v109, v108
    v_mov_b32 v141, v140
    s_nop 0
    v_permlane16_swap_b32 v108, v109
    v_permlane16_swap_b32 v140, v141
    v_mul_f32 v110, s68, v108
    v_mul_f32 v142, s68, v140
    v_mul_f32 v111, s68, v109
    v_mul_f32 v143, s68, v141
    v_fma_f32 v100, -v92, s68, -v111
    v_fma_f32 v132, -v124, s68, -v143
    v_fma_f32 v92, v92, s68, -v110
    v_fma_f32 v124, v124, s68, -v142
    v_fma_f32 v101, -v93, s68, -v111
    v_fma_f32 v133, -v125, s68, -v143
    v_fma_f32 v93, v93, s68, -v110
    v_fma_f32 v125, v125, s68, -v142
    v_fma_f32 v102, -v94, s68, -v111
    v_fma_f32 v134, -v126, s68, -v143
    v_fma_f32 v94, v94, s68, -v110
    v_fma_f32 v126, v126, s68, -v142
    v_fma_f32 v103, -v95, s68, -v111
    v_fma_f32 v135, -v127, s68, -v143
    v_fma_f32 v95, v95, s68, -v110
    v_fma_f32 v127, v127, s68, -v142
    v_fma_f32 v104, -v96, s68, -v111
    v_fma_f32 v136, -v128, s68, -v143
    v_fma_f32 v96, v96, s68, -v110
    v_fma_f32 v128, v128, s68, -v142
    v_fma_f32 v105, -v97, s68, -v111
    v_fma_f32 v137, -v129, s68, -v143
    v_fma_f32 v97, v97, s68, -v110
    v_fma_f32 v129, v129, s68, -v142
    v_fma_f32 v106, -v98, s68, -v111
    v_fma_f32 v138, -v130, s68, -v143
    v_fma_f32 v98, v98, s68, -v110
    v_fma_f32 v130, v130, s68, -v142
    v_fma_f32 v107, -v99, s68, -v111
    v_fma_f32 v139, -v131, s68, -v143
    v_fma_f32 v99, v99, s68, -v110
    v_fma_f32 v131, v131, s68, -v142
    v_exp_f32 v92, v92
    v_exp_f32 v124, v124
    v_exp_f32 v100, v100
    v_exp_f32 v132, v132
    v_exp_f32 v93, v93
    v_exp_f32 v125, v125
    v_exp_f32 v101, v101
    v_exp_f32 v133, v133
    v_exp_f32 v94, v94
    v_exp_f32 v126, v126
    v_exp_f32 v102, v102
    v_exp_f32 v134, v134
    v_exp_f32 v95, v95
    v_exp_f32 v127, v127
    v_exp_f32 v103, v103
    v_exp_f32 v135, v135
    v_exp_f32 v96, v96
    v_exp_f32 v128, v128
    v_exp_f32 v104, v104
    v_exp_f32 v136, v136
    v_exp_f32 v97, v97
    v_exp_f32 v129, v129
    v_exp_f32 v105, v105
    v_exp_f32 v137, v137
    v_exp_f32 v98, v98
    v_exp_f32 v130, v130
    v_exp_f32 v106, v106
    v_exp_f32 v138, v138
    v_exp_f32 v99, v99
    v_exp_f32 v131, v131
    v_exp_f32 v107, v107
    v_exp_f32 v139, v139
    v_add_f32 v108, v92, v93
    v_add_f32 v140, v124, v125
    v_add_f32 v109, v100, v101
    v_add_f32 v141, v132, v133
    v_add_f32 v110, v94, v95
    v_add_f32 v142, v126, v127
    v_add_f32 v111, v102, v103
    v_add_f32 v143, v134, v135
    v_add_f32 v108, v108, v96
    v_add_f32 v140, v140, v128
    v_add_f32 v109, v109, v104
    v_add_f32 v141, v141, v136
    v_add_f32 v110, v110, v97
    v_add_f32 v142, v142, v129
    v_add_f32 v111, v111, v105
    v_add_f32 v143, v143, v137
    v_add_f32 v108, v108, v98
    v_add_f32 v140, v140, v130
    v_add_f32 v109, v109, v106
    v_add_f32 v141, v141, v138
    v_add_f32 v110, v110, v99
    v_add_f32 v142, v142, v131
    v_add_f32 v111, v111, v107
    v_add_f32 v143, v143, v139
    v_add_f32 v108, v108, v110
    v_add_f32 v140, v140, v142
    v_add_f32 v109, v109, v111
    v_add_f32 v141, v141, v143
    s_nop 0
    v_permlane16_swap_b32 v108, v109
    v_permlane16_swap_b32 v140, v141
    v_add_f32 v108, v108, v109
    v_add_f32 v140, v140, v141
    v_mov_b32 v109, v108
    v_mov_b32 v141, v140
    s_nop 0
    v_permlane32_swap_b32 v108, v109
    v_permlane32_swap_b32 v140, v141
    v_add_f32 v108, v108, v109
    v_add_f32 v140, v140, v141
    v_mov_b32 v109, v108
    v_mov_b32 v141, v140
    s_nop 0
    v_permlane16_swap_b32 v108, v109
    v_permlane16_swap_b32 v140, v141
    v_rcp_f32 v108, v108
    v_rcp_f32 v140, v140
    v_rcp_f32 v109, v109
    v_rcp_f32 v141, v141
    v_mul_f32 v92, v92, v108
    v_mul_f32 v124, v124, v140
    v_mul_f32 v100, v100, v109
    v_mul_f32 v132, v132, v141
    v_mul_f32 v93, v93, v108
    v_mul_f32 v125, v125, v140
    v_mul_f32 v101, v101, v109
    v_mul_f32 v133, v133, v141
    v_mul_f32 v94, v94, v108
    v_mul_f32 v126, v126, v140
    v_mul_f32 v102, v102, v109
    v_mul_f32 v134, v134, v141
    v_mul_f32 v95, v95, v108
    v_mul_f32 v127, v127, v140
    v_mul_f32 v103, v103, v109
    v_mul_f32 v135, v135, v141
    v_mul_f32 v96, v96, v108
    v_mul_f32 v128, v128, v140
    v_mul_f32 v104, v104, v109
    v_mul_f32 v136, v136, v141
    v_mul_f32 v97, v97, v108
    v_mul_f32 v129, v129, v140
    v_mul_f32 v105, v105, v109
    v_mul_f32 v137, v137, v141
    v_mul_f32 v98, v98, v108
    v_mul_f32 v130, v130, v140
    v_mul_f32 v106, v106, v109
    v_mul_f32 v138, v138, v141
    v_mul_f32 v99, v99, v108
    v_mul_f32 v131, v131, v140
    v_mul_f32 v107, v107, v109
    v_mul_f32 v139, v139, v141
    v_cvt_pk_bf16_f32 v112, v92, v93
    v_cvt_pk_bf16_f32 v144, v124, v125
    v_cvt_pk_bf16_f32 v116, v100, v101
    v_cvt_pk_bf16_f32 v148, v132, v133
    v_cvt_pk_bf16_f32 v113, v94, v95
    v_cvt_pk_bf16_f32 v145, v126, v127
    v_cvt_pk_bf16_f32 v117, v102, v103
    v_cvt_pk_bf16_f32 v149, v134, v135
    v_cvt_pk_bf16_f32 v114, v96, v97
    v_cvt_pk_bf16_f32 v146, v128, v129
    v_cvt_pk_bf16_f32 v118, v104, v105
    v_cvt_pk_bf16_f32 v150, v136, v137
    v_cvt_pk_bf16_f32 v115, v98, v99
    v_cvt_pk_bf16_f32 v147, v130, v131
    v_cvt_pk_bf16_f32 v119, v106, v107
    v_cvt_pk_bf16_f32 v151, v138, v139
    ds_write_b128 v224, v[112:115] offset:0
    ds_write_b128 v224, v[144:147] offset:2048
    ds_write_b128 v224, v[116:119] offset:1024
    ds_write_b128 v224, v[148:151] offset:3072
    s_cmp_eq_u32 s69, 1
    s_cbranch_scc1 G2_xd
    s_mov_b32 s52, 0
    s_mov_b32 s69, 2
G2_hw:
    buffer_load_dword v19, v17, s[16:19], s53 offen sc1
    s_waitcnt vmcnt(0)
    v_cmp_eq_u32 vcc, v14, v19
    s_nop 0
    s_cmp_eq_u64 vcc, -1
    s_cbranch_scc1 G2_xl
    s_sleep 1
    s_add_u32 s52, s52, 1
    s_cmp_lt_u32 s52, 0x100000
    s_cbranch_scc1 G2_hw
    s_branch G2_xl
G2_xd:
    s_waitcnt lgkmcnt(0)
    v_mov_b32 v20, 0
    v_mov_b32 v21, 147456
    v_add_u32 v20, 1, v20
    ds_write_b32 v21, v20
    s_barrier
    ds_read_b64_tr_b16 v[88:89], v2 offset:0
    ds_read_b64_tr_b16 v[90:91], v2 offset:2048
    ds_read_b64_tr_b16 v[92:93], v3 offset:0
    ds_read_b64_tr_b16 v[94:95], v3 offset:2048
    ds_read_b64_tr_b16 v[96:97], v4 offset:0
    ds_read_b64_tr_b16 v[98:99], v4 offset:2048
    ds_read_b64_tr_b16 v[100:101], v5 offset:0
    ds_read_b64_tr_b16 v[102:103], v5 offset:2048
    ds_read_b64_tr_b16 v[104:105], v2 offset:8192
    ds_read_b64_tr_b16 v[106:107], v2 offset:10240
    ds_read_b64_tr_b16 v[108:109], v3 offset:8192
    ds_read_b64_tr_b16 v[110:111], v3 offset:10240
    ds_read_b64_tr_b16 v[112:113], v4 offset:8192
    ds_read_b64_tr_b16 v[114:115], v4 offset:10240
    ds_read_b64_tr_b16 v[116:117], v5 offset:8192
    ds_read_b64_tr_b16 v[118:119], v5 offset:10240
    s_lshr_b32 s36, s72, 2
.p2align 6
G2_loop1:
    s_waitcnt lgkmcnt(8) vmcnt(12)
    v_mfma_f32_16x16x32_bf16 v[152:155], v[88:91], v[24:27], v[152:155]
    ds_read_b64_tr_b16 v[120:121], v2 offset:4096
    ds_read_b64_tr_b16 v[122:123], v2 offset:6144
    v_mfma_f32_16x16x32_bf16 v[156:159], v[88:91], v[28:31], v[156:159]
    ds_read_b64_tr_b16 v[124:125], v3 offset:4096
    ds_read_b64_tr_b16 v[126:127], v3 offset:6144
    v_mfma_f32_16x16x32_bf16 v[160:163], v[92:95], v[24:27], v[160:163]
    ds_read_b64_tr_b16 v[128:129], v4 offset:4096
    ds_read_b64_tr_b16 v[130:131], v4 offset:6144
    v_mfma_f32_16x16x32_bf16 v[164:167], v[92:95], v[28:31], v[164:167]
    ds_read_b64_tr_b16 v[132:133], v5 offset:4096
    v_mfma_f32_16x16x32_bf16 v[168:171], v[96:99], v[24:27], v[168:171]
    ds_read_b64_tr_b16 v[134:135], v5 offset:6144
    v_mfma_f32_16x16x32_bf16 v[172:175], v[96:99], v[28:31], v[172:175]
    s_add_u32 s32, s32, 8192
    buffer_load_dwordx4 v[80:83], v10, s[8:11], s32 offen sc1
    v_mfma_f32_16x16x32_bf16 v[176:179], v[100:103], v[24:27], v[176:179]
    buffer_load_dwordx4 v[84:87], v10, s[8:11], s32 offen offset:1024 sc1
    v_mfma_f32_16x16x32_bf16 v[180:183], v[100:103], v[28:31], v[180:183]
    s_waitcnt lgkmcnt(8)
    v_mfma_f32_16x16x32_bf16 v[184:187], v[104:107], v[24:27], v[184:187]
    ds_read_b64_tr_b16 v[136:137], v2 offset:12288
    ds_read_b64_tr_b16 v[138:139], v2 offset:14336
    v_mfma_f32_16x16x32_bf16 v[188:191], v[104:107], v[28:31], v[188:191]
    ds_read_b64_tr_b16 v[140:141], v3 offset:12288
    v_mfma_f32_16x16x32_bf16 v[192:195], v[108:111], v[24:27], v[192:195]
    ds_read_b64_tr_b16 v[142:143], v3 offset:14336
    v_mfma_f32_16x16x32_bf16 v[196:199], v[108:111], v[28:31], v[196:199]
    ds_read_b64_tr_b16 v[144:145], v4 offset:12288
    v_mfma_f32_16x16x32_bf16 v[200:203], v[112:115], v[24:27], v[200:203]
    ds_read_b64_tr_b16 v[146:147], v4 offset:14336
    v_mfma_f32_16x16x32_bf16 v[204:207], v[112:115], v[28:31], v[204:207]
    ds_read_b64_tr_b16 v[148:149], v5 offset:12288
    v_mfma_f32_16x16x32_bf16 v[208:211], v[116:119], v[24:27], v[208:211]
    ds_read_b64_tr_b16 v[150:151], v5 offset:14336
    v_mfma_f32_16x16x32_bf16 v[212:215], v[116:119], v[28:31], v[212:215]
    s_waitcnt lgkmcnt(8) vmcnt(12)
    v_add_u32 v20, 1, v20
    ds_write_b32 v21, v20
    s_barrier
    s_add_u32 s33, s33, 16384
    s_cmp_ge_u32 s33, 114688
    s_cselect_b32 s33, 0, s33
    v_add_u32 v2, s33, v6
    v_add_u32 v3, s33, v7
    v_add_u32 v4, s33, v8
    v_add_u32 v5, s33, v9
    s_cmp_eq_u32 s36, 1
    s_cselect_b32 s51, s34, 0
    s_add_u32 s32, s32, s51
    v_mfma_f32_16x16x32_bf16 v[152:155], v[120:123], v[32:35], v[152:155]
    ds_read_b64_tr_b16 v[88:89], v2 offset:0
    ds_read_b64_tr_b16 v[90:91], v2 offset:2048
    v_mfma_f32_16x16x32_bf16 v[156:159], v[120:123], v[36:39], v[156:159]
    ds_read_b64_tr_b16 v[92:93], v3 offset:0
    ds_read_b64_tr_b16 v[94:95], v3 offset:2048
    v_mfma_f32_16x16x32_bf16 v[160:163], v[124:127], v[32:35], v[160:163]
    ds_read_b64_tr_b16 v[96:97], v4 offset:0
    ds_read_b64_tr_b16 v[98:99], v4 offset:2048
    v_mfma_f32_16x16x32_bf16 v[164:167], v[124:127], v[36:39], v[164:167]
    ds_read_b64_tr_b16 v[100:101], v5 offset:0
    v_mfma_f32_16x16x32_bf16 v[168:171], v[128:131], v[32:35], v[168:171]
    ds_read_b64_tr_b16 v[102:103], v5 offset:2048
    v_mfma_f32_16x16x32_bf16 v[172:175], v[128:131], v[36:39], v[172:175]
    s_add_u32 s32, s32, 8192
    buffer_load_dwordx4 v[24:27], v10, s[8:11], s32 offen sc1
    v_mfma_f32_16x16x32_bf16 v[176:179], v[132:135], v[32:35], v[176:179]
    buffer_load_dwordx4 v[28:31], v10, s[8:11], s32 offen offset:1024 sc1
    v_mfma_f32_16x16x32_bf16 v[180:183], v[132:135], v[36:39], v[180:183]
    s_waitcnt lgkmcnt(8)
    v_mfma_f32_16x16x32_bf16 v[184:187], v[136:139], v[32:35], v[184:187]
    ds_read_b64_tr_b16 v[104:105], v2 offset:8192
    ds_read_b64_tr_b16 v[106:107], v2 offset:10240
    v_mfma_f32_16x16x32_bf16 v[188:191], v[136:139], v[36:39], v[188:191]
    ds_read_b64_tr_b16 v[108:109], v3 offset:8192
    v_mfma_f32_16x16x32_bf16 v[192:195], v[140:143], v[32:35], v[192:195]
    ds_read_b64_tr_b16 v[110:111], v3 offset:10240
    v_mfma_f32_16x16x32_bf16 v[196:199], v[140:143], v[36:39], v[196:199]
    ds_read_b64_tr_b16 v[112:113], v4 offset:8192
    v_mfma_f32_16x16x32_bf16 v[200:203], v[144:147], v[32:35], v[200:203]
    ds_read_b64_tr_b16 v[114:115], v4 offset:10240
    v_mfma_f32_16x16x32_bf16 v[204:207], v[144:147], v[36:39], v[204:207]
    ds_read_b64_tr_b16 v[116:117], v5 offset:8192
    v_mfma_f32_16x16x32_bf16 v[208:211], v[148:151], v[32:35], v[208:211]
    ds_read_b64_tr_b16 v[118:119], v5 offset:10240
    v_mfma_f32_16x16x32_bf16 v[212:215], v[148:151], v[36:39], v[212:215]
    s_waitcnt lgkmcnt(8) vmcnt(12)
    v_mfma_f32_16x16x32_bf16 v[152:155], v[88:91], v[40:43], v[152:155]
    ds_read_b64_tr_b16 v[120:121], v2 offset:4096
    ds_read_b64_tr_b16 v[122:123], v2 offset:6144
    v_mfma_f32_16x16x32_bf16 v[156:159], v[88:91], v[44:47], v[156:159]
    ds_read_b64_tr_b16 v[124:125], v3 offset:4096
    ds_read_b64_tr_b16 v[126:127], v3 offset:6144
    v_mfma_f32_16x16x32_bf16 v[160:163], v[92:95], v[40:43], v[160:163]
    ds_read_b64_tr_b16 v[128:129], v4 offset:4096
    ds_read_b64_tr_b16 v[130:131], v4 offset:6144
    v_mfma_f32_16x16x32_bf16 v[164:167], v[92:95], v[44:47], v[164:167]
    ds_read_b64_tr_b16 v[132:133], v5 offset:4096
    v_mfma_f32_16x16x32_bf16 v[168:171], v[96:99], v[40:43], v[168:171]
    ds_read_b64_tr_b16 v[134:135], v5 offset:6144
    v_mfma_f32_16x16x32_bf16 v[172:175], v[96:99], v[44:47], v[172:175]
    s_add_u32 s32, s32, 8192
    buffer_load_dwordx4 v[32:35], v10, s[8:11], s32 offen sc1
    v_mfma_f32_16x16x32_bf16 v[176:179], v[100:103], v[40:43], v[176:179]
    buffer_load_dwordx4 v[36:39], v10, s[8:11], s32 offen offset:1024 sc1
    v_mfma_f32_16x16x32_bf16 v[180:183], v[100:103], v[44:47], v[180:183]
    s_waitcnt lgkmcnt(8)
    v_mfma_f32_16x16x32_bf16 v[184:187], v[104:107], v[40:43], v[184:187]
    ds_read_b64_tr_b16 v[136:137], v2 offset:12288
    ds_read_b64_tr_b16 v[138:139], v2 offset:14336
    v_mfma_f32_16x16x32_bf16 v[188:191], v[104:107], v[44:47], v[188:191]
    ds_read_b64_tr_b16 v[140:141], v3 offset:12288
    v_mfma_f32_16x16x32_bf16 v[192:195], v[108:111], v[40:43], v[192:195]
    ds_read_b64_tr_b16 v[142:143], v3 offset:14336
    v_mfma_f32_16x16x32_bf16 v[196:199], v[108:111], v[44:47], v[196:199]
    ds_read_b64_tr_b16 v[144:145], v4 offset:12288
    v_mfma_f32_16x16x32_bf16 v[200:203], v[112:115], v[40:43], v[200:203]
    ds_read_b64_tr_b16 v[146:147], v4 offset:14336
    v_mfma_f32_16x16x32_bf16 v[204:207], v[112:115], v[44:47], v[204:207]
    ds_read_b64_tr_b16 v[148:149], v5 offset:12288
    v_mfma_f32_16x16x32_bf16 v[208:211], v[116:119], v[40:43], v[208:211]
    ds_read_b64_tr_b16 v[150:151], v5 offset:14336
    v_mfma_f32_16x16x32_bf16 v[212:215], v[116:119], v[44:47], v[212:215]
    s_waitcnt lgkmcnt(8) vmcnt(12)
    v_add_u32 v20, 1, v20
    ds_write_b32 v21, v20
    s_barrier
    s_add_u32 s33, s33, 16384
    s_cmp_ge_u32 s33, 114688
    s_cselect_b32 s33, 0, s33
    v_add_u32 v2, s33, v6
    v_add_u32 v3, s33, v7
    v_add_u32 v4, s33, v8
    v_add_u32 v5, s33, v9
    v_mfma_f32_16x16x32_bf16 v[152:155], v[120:123], v[48:51], v[152:155]
    ds_read_b64_tr_b16 v[88:89], v2 offset:0
    ds_read_b64_tr_b16 v[90:91], v2 offset:2048
    v_mfma_f32_16x16x32_bf16 v[156:159], v[120:123], v[52:55], v[156:159]
    ds_read_b64_tr_b16 v[92:93], v3 offset:0
    ds_read_b64_tr_b16 v[94:95], v3 offset:2048
    v_mfma_f32_16x16x32_bf16 v[160:163], v[124:127], v[48:51], v[160:163]
    ds_read_b64_tr_b16 v[96:97], v4 offset:0
    ds_read_b64_tr_b16 v[98:99], v4 offset:2048
    v_mfma_f32_16x16x32_bf16 v[164:167], v[124:127], v[52:55], v[164:167]
    ds_read_b64_tr_b16 v[100:101], v5 offset:0
    v_mfma_f32_16x16x32_bf16 v[168:171], v[128:131], v[48:51], v[168:171]
    ds_read_b64_tr_b16 v[102:103], v5 offset:2048
    v_mfma_f32_16x16x32_bf16 v[172:175], v[128:131], v[52:55], v[172:175]
    s_add_u32 s32, s32, 8192
    buffer_load_dwordx4 v[40:43], v10, s[8:11], s32 offen sc1
    v_mfma_f32_16x16x32_bf16 v[176:179], v[132:135], v[48:51], v[176:179]
    buffer_load_dwordx4 v[44:47], v10, s[8:11], s32 offen offset:1024 sc1
    v_mfma_f32_16x16x32_bf16 v[180:183], v[132:135], v[52:55], v[180:183]
    s_waitcnt lgkmcnt(8)
    v_mfma_f32_16x16x32_bf16 v[184:187], v[136:139], v[48:51], v[184:187]
    ds_read_b64_tr_b16 v[104:105], v2 offset:8192
    ds_read_b64_tr_b16 v[106:107], v2 offset:10240
    v_mfma_f32_16x16x32_bf16 v[188:191], v[136:139], v[52:55], v[188:191]
    ds_read_b64_tr_b16 v[108:109], v3 offset:8192
    v_mfma_f32_16x16x32_bf16 v[192:195], v[140:143], v[48:51], v[192:195]
    ds_read_b64_tr_b16 v[110:111], v3 offset:10240
    v_mfma_f32_16x16x32_bf16 v[196:199], v[140:143], v[52:55], v[196:199]
    ds_read_b64_tr_b16 v[112:113], v4 offset:8192
    v_mfma_f32_16x16x32_bf16 v[200:203], v[144:147], v[48:51], v[200:203]
    ds_read_b64_tr_b16 v[114:115], v4 offset:10240
    v_mfma_f32_16x16x32_bf16 v[204:207], v[144:147], v[52:55], v[204:207]
    ds_read_b64_tr_b16 v[116:117], v5 offset:8192
    v_mfma_f32_16x16x32_bf16 v[208:211], v[148:151], v[48:51], v[208:211]
    ds_read_b64_tr_b16 v[118:119], v5 offset:10240
    v_mfma_f32_16x16x32_bf16 v[212:215], v[148:151], v[52:55], v[212:215]
    s_waitcnt lgkmcnt(8) vmcnt(12)
    v_mfma_f32_16x16x32_bf16 v[152:155], v[88:91], v[56:59], v[152:155]
    ds_read_b64_tr_b16 v[120:121], v2 offset:4096
    ds_read_b64_tr_b16 v[122:123], v2 offset:6144
    v_mfma_f32_16x16x32_bf16 v[156:159], v[88:91], v[60:63], v[156:159]
    ds_read_b64_tr_b16 v[124:125], v3 offset:4096
    ds_read_b64_tr_b16 v[126:127], v3 offset:6144
    v_mfma_f32_16x16x32_bf16 v[160:163], v[92:95], v[56:59], v[160:163]
    ds_read_b64_tr_b16 v[128:129], v4 offset:4096
    ds_read_b64_tr_b16 v[130:131], v4 offset:6144
    v_mfma_f32_16x16x32_bf16 v[164:167], v[92:95], v[60:63], v[164:167]
    ds_read_b64_tr_b16 v[132:133], v5 offset:4096
    v_mfma_f32_16x16x32_bf16 v[168:171], v[96:99], v[56:59], v[168:171]
    ds_read_b64_tr_b16 v[134:135], v5 offset:6144
    v_mfma_f32_16x16x32_bf16 v[172:175], v[96:99], v[60:63], v[172:175]
    s_add_u32 s32, s32, 8192
    buffer_load_dwordx4 v[48:51], v10, s[8:11], s32 offen sc1
    v_mfma_f32_16x16x32_bf16 v[176:179], v[100:103], v[56:59], v[176:179]
    buffer_load_dwordx4 v[52:55], v10, s[8:11], s32 offen offset:1024 sc1
    v_mfma_f32_16x16x32_bf16 v[180:183], v[100:103], v[60:63], v[180:183]
    s_waitcnt lgkmcnt(8)
    v_mfma_f32_16x16x32_bf16 v[184:187], v[104:107], v[56:59], v[184:187]
    ds_read_b64_tr_b16 v[136:137], v2 offset:12288
    ds_read_b64_tr_b16 v[138:139], v2 offset:14336
    v_mfma_f32_16x16x32_bf16 v[188:191], v[104:107], v[60:63], v[188:191]
    ds_read_b64_tr_b16 v[140:141], v3 offset:12288
    v_mfma_f32_16x16x32_bf16 v[192:195], v[108:111], v[56:59], v[192:195]
    ds_read_b64_tr_b16 v[142:143], v3 offset:14336
    v_mfma_f32_16x16x32_bf16 v[196:199], v[108:111], v[60:63], v[196:199]
    ds_read_b64_tr_b16 v[144:145], v4 offset:12288
    v_mfma_f32_16x16x32_bf16 v[200:203], v[112:115], v[56:59], v[200:203]
    ds_read_b64_tr_b16 v[146:147], v4 offset:14336
    v_mfma_f32_16x16x32_bf16 v[204:207], v[112:115], v[60:63], v[204:207]
    ds_read_b64_tr_b16 v[148:149], v5 offset:12288
    v_mfma_f32_16x16x32_bf16 v[208:211], v[116:119], v[56:59], v[208:211]
    ds_read_b64_tr_b16 v[150:151], v5 offset:14336
    v_mfma_f32_16x16x32_bf16 v[212:215], v[116:119], v[60:63], v[212:215]
    s_waitcnt lgkmcnt(8) vmcnt(12)
    v_add_u32 v20, 1, v20
    ds_write_b32 v21, v20
    s_barrier
    s_add_u32 s33, s33, 16384
    s_cmp_ge_u32 s33, 114688
    s_cselect_b32 s33, 0, s33
    v_add_u32 v2, s33, v6
    v_add_u32 v3, s33, v7
    v_add_u32 v4, s33, v8
    v_add_u32 v5, s33, v9
    v_mfma_f32_16x16x32_bf16 v[152:155], v[120:123], v[64:67], v[152:155]
    ds_read_b64_tr_b16 v[88:89], v2 offset:0
    ds_read_b64_tr_b16 v[90:91], v2 offset:2048
    v_mfma_f32_16x16x32_bf16 v[156:159], v[120:123], v[68:71], v[156:159]
    ds_read_b64_tr_b16 v[92:93], v3 offset:0
    ds_read_b64_tr_b16 v[94:95], v3 offset:2048
    v_mfma_f32_16x16x32_bf16 v[160:163], v[124:127], v[64:67], v[160:163]
    ds_read_b64_tr_b16 v[96:97], v4 offset:0
    ds_read_b64_tr_b16 v[98:99], v4 offset:2048
    v_mfma_f32_16x16x32_bf16 v[164:167], v[124:127], v[68:71], v[164:167]
    ds_read_b64_tr_b16 v[100:101], v5 offset:0
    v_mfma_f32_16x16x32_bf16 v[168:171], v[128:131], v[64:67], v[168:171]
    ds_read_b64_tr_b16 v[102:103], v5 offset:2048
    v_mfma_f32_16x16x32_bf16 v[172:175], v[128:131], v[68:71], v[172:175]
    s_add_u32 s32, s32, 8192
    buffer_load_dwordx4 v[56:59], v10, s[8:11], s32 offen sc1
    v_mfma_f32_16x16x32_bf16 v[176:179], v[132:135], v[64:67], v[176:179]
    buffer_load_dwordx4 v[60:63], v10, s[8:11], s32 offen offset:1024 sc1
    v_mfma_f32_16x16x32_bf16 v[180:183], v[132:135], v[68:71], v[180:183]
    s_waitcnt lgkmcnt(8)
    v_mfma_f32_16x16x32_bf16 v[184:187], v[136:139], v[64:67], v[184:187]
    ds_read_b64_tr_b16 v[104:105], v2 offset:8192
    ds_read_b64_tr_b16 v[106:107], v2 offset:10240
    v_mfma_f32_16x16x32_bf16 v[188:191], v[136:139], v[68:71], v[188:191]
    ds_read_b64_tr_b16 v[108:109], v3 offset:8192
    v_mfma_f32_16x16x32_bf16 v[192:195], v[140:143], v[64:67], v[192:195]
    ds_read_b64_tr_b16 v[110:111], v3 offset:10240
    v_mfma_f32_16x16x32_bf16 v[196:199], v[140:143], v[68:71], v[196:199]
    ds_read_b64_tr_b16 v[112:113], v4 offset:8192
    v_mfma_f32_16x16x32_bf16 v[200:203], v[144:147], v[64:67], v[200:203]
    ds_read_b64_tr_b16 v[114:115], v4 offset:10240
    v_mfma_f32_16x16x32_bf16 v[204:207], v[144:147], v[68:71], v[204:207]
    ds_read_b64_tr_b16 v[116:117], v5 offset:8192
    v_mfma_f32_16x16x32_bf16 v[208:211], v[148:151], v[64:67], v[208:211]
    ds_read_b64_tr_b16 v[118:119], v5 offset:10240
    v_mfma_f32_16x16x32_bf16 v[212:215], v[148:151], v[68:71], v[212:215]
    s_waitcnt lgkmcnt(8) vmcnt(12)
    v_mfma_f32_16x16x32_bf16 v[152:155], v[88:91], v[72:75], v[152:155]
    ds_read_b64_tr_b16 v[120:121], v2 offset:4096
    ds_read_b64_tr_b16 v[122:123], v2 offset:6144
    v_mfma_f32_16x16x32_bf16 v[156:159], v[88:91], v[76:79], v[156:159]
    ds_read_b64_tr_b16 v[124:125], v3 offset:4096
    ds_read_b64_tr_b16 v[126:127], v3 offset:6144
    v_mfma_f32_16x16x32_bf16 v[160:163], v[92:95], v[72:75], v[160:163]
    ds_read_b64_tr_b16 v[128:129], v4 offset:4096
    ds_read_b64_tr_b16 v[130:131], v4 offset:6144
    v_mfma_f32_16x16x32_bf16 v[164:167], v[92:95], v[76:79], v[164:167]
    ds_read_b64_tr_b16 v[132:133], v5 offset:4096
    v_mfma_f32_16x16x32_bf16 v[168:171], v[96:99], v[72:75], v[168:171]
    ds_read_b64_tr_b16 v[134:135], v5 offset:6144
    v_mfma_f32_16x16x32_bf16 v[172:175], v[96:99], v[76:79], v[172:175]
    s_add_u32 s32, s32, 8192
    buffer_load_dwordx4 v[64:67], v10, s[8:11], s32 offen sc1
    v_mfma_f32_16x16x32_bf16 v[176:179], v[100:103], v[72:75], v[176:179]
    buffer_load_dwordx4 v[68:71], v10, s[8:11], s32 offen offset:1024 sc1
    v_mfma_f32_16x16x32_bf16 v[180:183], v[100:103], v[76:79], v[180:183]
    s_waitcnt lgkmcnt(8)
    v_mfma_f32_16x16x32_bf16 v[184:187], v[104:107], v[72:75], v[184:187]
    ds_read_b64_tr_b16 v[136:137], v2 offset:12288
    ds_read_b64_tr_b16 v[138:139], v2 offset:14336
    v_mfma_f32_16x16x32_bf16 v[188:191], v[104:107], v[76:79], v[188:191]
    ds_read_b64_tr_b16 v[140:141], v3 offset:12288
    v_mfma_f32_16x16x32_bf16 v[192:195], v[108:111], v[72:75], v[192:195]
    ds_read_b64_tr_b16 v[142:143], v3 offset:14336
    v_mfma_f32_16x16x32_bf16 v[196:199], v[108:111], v[76:79], v[196:199]
    ds_read_b64_tr_b16 v[144:145], v4 offset:12288
    v_mfma_f32_16x16x32_bf16 v[200:203], v[112:115], v[72:75], v[200:203]
    ds_read_b64_tr_b16 v[146:147], v4 offset:14336
    v_mfma_f32_16x16x32_bf16 v[204:207], v[112:115], v[76:79], v[204:207]
    ds_read_b64_tr_b16 v[148:149], v5 offset:12288
    v_mfma_f32_16x16x32_bf16 v[208:211], v[116:119], v[72:75], v[208:211]
    ds_read_b64_tr_b16 v[150:151], v5 offset:14336
    v_mfma_f32_16x16x32_bf16 v[212:215], v[116:119], v[76:79], v[212:215]
    s_waitcnt lgkmcnt(8) vmcnt(12)
    v_add_u32 v20, 1, v20
    ds_write_b32 v21, v20
    s_barrier
    s_add_u32 s33, s33, 16384
    s_cmp_ge_u32 s33, 114688
    s_cselect_b32 s33, 0, s33
    v_add_u32 v2, s33, v6
    v_add_u32 v3, s33, v7
    v_add_u32 v4, s33, v8
    v_add_u32 v5, s33, v9
    v_mfma_f32_16x16x32_bf16 v[152:155], v[120:123], v[80:83], v[152:155]
    ds_read_b64_tr_b16 v[88:89], v2 offset:0
    ds_read_b64_tr_b16 v[90:91], v2 offset:2048
    v_mfma_f32_16x16x32_bf16 v[156:159], v[120:123], v[84:87], v[156:159]
    ds_read_b64_tr_b16 v[92:93], v3 offset:0
    ds_read_b64_tr_b16 v[94:95], v3 offset:2048
    v_mfma_f32_16x16x32_bf16 v[160:163], v[124:127], v[80:83], v[160:163]
    ds_read_b64_tr_b16 v[96:97], v4 offset:0
    ds_read_b64_tr_b16 v[98:99], v4 offset:2048
    v_mfma_f32_16x16x32_bf16 v[164:167], v[124:127], v[84:87], v[164:167]
    ds_read_b64_tr_b16 v[100:101], v5 offset:0
    v_mfma_f32_16x16x32_bf16 v[168:171], v[128:131], v[80:83], v[168:171]
    ds_read_b64_tr_b16 v[102:103], v5 offset:2048
    v_mfma_f32_16x16x32_bf16 v[172:175], v[128:131], v[84:87], v[172:175]
    s_add_u32 s32, s32, 8192
    buffer_load_dwordx4 v[72:75], v10, s[8:11], s32 offen sc1
    v_mfma_f32_16x16x32_bf16 v[176:179], v[132:135], v[80:83], v[176:179]
    buffer_load_dwordx4 v[76:79], v10, s[8:11], s32 offen offset:1024 sc1
    v_mfma_f32_16x16x32_bf16 v[180:183], v[132:135], v[84:87], v[180:183]
    s_waitcnt lgkmcnt(8)
    v_mfma_f32_16x16x32_bf16 v[184:187], v[136:139], v[80:83], v[184:187]
    ds_read_b64_tr_b16 v[104:105], v2 offset:8192
    ds_read_b64_tr_b16 v[106:107], v2 offset:10240
    v_mfma_f32_16x16x32_bf16 v[188:191], v[136:139], v[84:87], v[188:191]
    ds_read_b64_tr_b16 v[108:109], v3 offset:8192
    v_mfma_f32_16x16x32_bf16 v[192:195], v[140:143], v[80:83], v[192:195]
    ds_read_b64_tr_b16 v[110:111], v3 offset:10240
    v_mfma_f32_16x16x32_bf16 v[196:199], v[140:143], v[84:87], v[196:199]
    ds_read_b64_tr_b16 v[112:113], v4 offset:8192
    v_mfma_f32_16x16x32_bf16 v[200:203], v[144:147], v[80:83], v[200:203]
    ds_read_b64_tr_b16 v[114:115], v4 offset:10240
    v_mfma_f32_16x16x32_bf16 v[204:207], v[144:147], v[84:87], v[204:207]
    ds_read_b64_tr_b16 v[116:117], v5 offset:8192
    v_mfma_f32_16x16x32_bf16 v[208:211], v[148:151], v[80:83], v[208:211]
    ds_read_b64_tr_b16 v[118:119], v5 offset:10240
    v_mfma_f32_16x16x32_bf16 v[212:215], v[148:151], v[84:87], v[212:215]
    s_sub_u32 s36, s36, 1
    s_cmp_lg_u32 s36, 0
    s_cbranch_scc1 G2_loop1
    ds_write_b128 v12, v[184:187] offset:0
    ds_write_b128 v12, v[188:191] offset:1024
    ds_write_b128 v12, v[192:195] offset:2048
    ds_write_b128 v12, v[196:199] offset:3072
    ds_write_b128 v12, v[200:203] offset:4096
    ds_write_b128 v12, v[204:207] offset:5120
    ds_write_b128 v12, v[208:211] offset:6144
    ds_write_b128 v12, v[212:215] offset:7168
    s_waitcnt lgkmcnt(8) vmcnt(12)
    v_mfma_f32_16x16x32_bf16 v[152:155], v[88:91], v[24:27], v[152:155]
    ds_read_b64_tr_b16 v[120:121], v2 offset:4096
    ds_read_b64_tr_b16 v[122:123], v2 offset:6144
    v_mfma_f32_16x16x32_bf16 v[156:159], v[88:91], v[28:31], v[156:159]
    ds_read_b64_tr_b16 v[124:125], v3 offset:4096
    ds_read_b64_tr_b16 v[126:127], v3 offset:6144
    v_mfma_f32_16x16x32_bf16 v[160:163], v[92:95], v[24:27], v[160:163]
    ds_read_b64_tr_b16 v[128:129], v4 offset:4096
    ds_read_b64_tr_b16 v[130:131], v4 offset:6144
    v_mfma_f32_16x16x32_bf16 v[164:167], v[92:95], v[28:31], v[164:167]
    ds_read_b64_tr_b16 v[132:133], v5 offset:4096
    v_mfma_f32_16x16x32_bf16 v[168:171], v[96:99], v[24:27], v[168:171]
    ds_read_b64_tr_b16 v[134:135], v5 offset:6144
    v_mfma_f32_16x16x32_bf16 v[172:175], v[96:99], v[28:31], v[172:175]
    s_add_u32 s32, s32, 8192
    buffer_load_dwordx4 v[80:83], v10, s[8:11], s32 offen sc1
    v_mfma_f32_16x16x32_bf16 v[176:179], v[100:103], v[24:27], v[176:179]
    buffer_load_dwordx4 v[84:87], v10, s[8:11], s32 offen offset:1024 sc1
    v_mfma_f32_16x16x32_bf16 v[180:183], v[100:103], v[28:31], v[180:183]
    s_waitcnt lgkmcnt(8) vmcnt(12)
    v_mfma_f32_16x16x32_bf16 v[152:155], v[104:107], v[32:35], v[152:155]
    ds_read_b64_tr_b16 v[136:137], v2 offset:12288
    ds_read_b64_tr_b16 v[138:139], v2 offset:14336
    v_mfma_f32_16x16x32_bf16 v[156:159], v[104:107], v[36:39], v[156:159]
    ds_read_b64_tr_b16 v[140:141], v3 offset:12288
    ds_read_b64_tr_b16 v[142:143], v3 offset:14336
    v_mfma_f32_16x16x32_bf16 v[160:163], v[108:111], v[32:35], v[160:163]
    ds_read_b64_tr_b16 v[144:145], v4 offset:12288
    ds_read_b64_tr_b16 v[146:147], v4 offset:14336
    v_mfma_f32_16x16x32_bf16 v[164:167], v[108:111], v[36:39], v[164:167]
    ds_read_b64_tr_b16 v[148:149], v5 offset:12288
    v_mfma_f32_16x16x32_bf16 v[168:171], v[112:115], v[32:35], v[168:171]
    ds_read_b64_tr_b16 v[150:151], v5 offset:14336
    v_mfma_f32_16x16x32_bf16 v[172:175], v[112:115], v[36:39], v[172:175]
    s_add_u32 s32, s32, 8192
    buffer_load_dwordx4 v[24:27], v10, s[8:11], s32 offen sc1
    v_mfma_f32_16x16x32_bf16 v[176:179], v[116:119], v[32:35], v[176:179]
    buffer_load_dwordx4 v[28:31], v10, s[8:11], s32 offen offset:1024 sc1
    v_mfma_f32_16x16x32_bf16 v[180:183], v[116:119], v[36:39], v[180:183]
    s_waitcnt lgkmcnt(8) vmcnt(12)
    v_add_u32 v20, 1, v20
    ds_write_b32 v21, v20
    s_barrier
    s_add_u32 s33, s33, 16384
    s_cmp_ge_u32 s33, 114688
    s_cselect_b32 s33, 0, s33
    v_add_u32 v2, s33, v6
    v_add_u32 v3, s33, v7
    v_add_u32 v4, s33, v8
    v_add_u32 v5, s33, v9
    v_mfma_f32_16x16x32_bf16 v[152:155], v[120:123], v[40:43], v[152:155]
    ds_read_b64_tr_b16 v[88:89], v2 offset:0
    ds_read_b64_tr_b16 v[90:91], v2 offset:2048
    v_mfma_f32_16x16x32_bf16 v[156:159], v[120:123], v[44:47], v[156:159]
    ds_read_b64_tr_b16 v[92:93], v3 offset:0
    ds_read_b64_tr_b16 v[94:95], v3 offset:2048
    v_mfma_f32_16x16x32_bf16 v[160:163], v[124:127], v[40:43], v[160:163]
    ds_read_b64_tr_b16 v[96:97], v4 offset:0
    ds_read_b64_tr_b16 v[98:99], v4 offset:2048
    v_mfma_f32_16x16x32_bf16 v[164:167], v[124:127], v[44:47], v[164:167]
    ds_read_b64_tr_b16 v[100:101], v5 offset:0
    v_mfma_f32_16x16x32_bf16 v[168:171], v[128:131], v[40:43], v[168:171]
    ds_read_b64_tr_b16 v[102:103], v5 offset:2048
    v_mfma_f32_16x16x32_bf16 v[172:175], v[128:131], v[44:47], v[172:175]
    s_add_u32 s32, s32, 8192
    buffer_load_dwordx4 v[32:35], v10, s[8:11], s32 offen sc1
    v_mfma_f32_16x16x32_bf16 v[176:179], v[132:135], v[40:43], v[176:179]
    buffer_load_dwordx4 v[36:39], v10, s[8:11], s32 offen offset:1024 sc1
    v_mfma_f32_16x16x32_bf16 v[180:183], v[132:135], v[44:47], v[180:183]
    s_waitcnt lgkmcnt(8) vmcnt(12)
    v_mfma_f32_16x16x32_bf16 v[152:155], v[136:139], v[48:51], v[152:155]
    ds_read_b64_tr_b16 v[104:105], v2 offset:8192
    ds_read_b64_tr_b16 v[106:107], v2 offset:10240
    v_mfma_f32_16x16x32_bf16 v[156:159], v[136:139], v[52:55], v[156:159]
    ds_read_b64_tr_b16 v[108:109], v3 offset:8192
    ds_read_b64_tr_b16 v[110:111], v3 offset:10240
    v_mfma_f32_16x16x32_bf16 v[160:163], v[140:143], v[48:51], v[160:163]
    ds_read_b64_tr_b16 v[112:113], v4 offset:8192
    ds_read_b64_tr_b16 v[114:115], v4 offset:10240
    v_mfma_f32_16x16x32_bf16 v[164:167], v[140:143], v[52:55], v[164:167]
    ds_read_b64_tr_b16 v[116:117], v5 offset:8192
    v_mfma_f32_16x16x32_bf16 v[168:171], v[144:147], v[48:51], v[168:171]
    ds_read_b64_tr_b16 v[118:119], v5 offset:10240
    v_mfma_f32_16x16x32_bf16 v[172:175], v[144:147], v[52:55], v[172:175]
    s_add_u32 s32, s32, 8192
    buffer_load_dwordx4 v[40:43], v10, s[8:11], s32 offen sc1
    v_mfma_f32_16x16x32_bf16 v[176:179], v[148:151], v[48:51], v[176:179]
    buffer_load_dwordx4 v[44:47], v10, s[8:11], s32 offen offset:1024 sc1
    v_mfma_f32_16x16x32_bf16 v[180:183], v[148:151], v[52:55], v[180:183]
    s_waitcnt lgkmcnt(8) vmcnt(12)
    v_mfma_f32_16x16x32_bf16 v[152:155], v[88:91], v[56:59], v[152:155]
    ds_read_b64_tr_b16 v[120:121], v2 offset:4096
    ds_read_b64_tr_b16 v[122:123], v2 offset:6144
    v_mfma_f32_16x16x32_bf16 v[156:159], v[88:91], v[60:63], v[156:159]
    ds_read_b64_tr_b16 v[124:125], v3 offset:4096
    ds_read_b64_tr_b16 v[126:127], v3 offset:6144
    v_mfma_f32_16x16x32_bf16 v[160:163], v[92:95], v[56:59], v[160:163]
    ds_read_b64_tr_b16 v[128:129], v4 offset:4096
    ds_read_b64_tr_b16 v[130:131], v4 offset:6144
    v_mfma_f32_16x16x32_bf16 v[164:167], v[92:95], v[60:63], v[164:167]
    ds_read_b64_tr_b16 v[132:133], v5 offset:4096
    v_mfma_f32_16x16x32_bf16 v[168:171], v[96:99], v[56:59], v[168:171]
    ds_read_b64_tr_b16 v[134:135], v5 offset:6144
    v_mfma_f32_16x16x32_bf16 v[172:175], v[96:99], v[60:63], v[172:175]
    s_add_u32 s32, s32, 8192
    buffer_load_dwordx4 v[48:51], v10, s[8:11], s32 offen sc1
    v_mfma_f32_16x16x32_bf16 v[176:179], v[100:103], v[56:59], v[176:179]
    buffer_load_dwordx4 v[52:55], v10, s[8:11], s32 offen offset:1024 sc1
    v_mfma_f32_16x16x32_bf16 v[180:183], v[100:103], v[60:63], v[180:183]
    s_waitcnt lgkmcnt(8) vmcnt(12)
    v_mfma_f32_16x16x32_bf16 v[152:155], v[104:107], v[64:67], v[152:155]
    ds_read_b64_tr_b16 v[136:137], v2 offset:12288
    ds_read_b64_tr_b16 v[138:139], v2 offset:14336
    v_mfma_f32_16x16x32_bf16 v[156:159], v[104:107], v[68:71], v[156:159]
    ds_read_b64_tr_b16 v[140:141], v3 offset:12288
    ds_read_b64_tr_b16 v[142:143], v3 offset:14336
    v_mfma_f32_16x16x32_bf16 v[160:163], v[108:111], v[64:67], v[160:163]
    ds_read_b64_tr_b16 v[144:145], v4 offset:12288
    ds_read_b64_tr_b16 v[146:147], v4 offset:14336
    v_mfma_f32_16x16x32_bf16 v[164:167], v[108:111], v[68:71], v[164:167]
    ds_read_b64_tr_b16 v[148:149], v5 offset:12288
    v_mfma_f32_16x16x32_bf16 v[168:171], v[112:115], v[64:67], v[168:171]
    ds_read_b64_tr_b16 v[150:151], v5 offset:14336
    v_mfma_f32_16x16x32_bf16 v[172:175], v[112:115], v[68:71], v[172:175]
    s_add_u32 s32, s32, 8192
    buffer_load_dwordx4 v[56:59], v10, s[8:11], s32 offen sc1
    v_mfma_f32_16x16x32_bf16 v[176:179], v[116:119], v[64:67], v[176:179]
    buffer_load_dwordx4 v[60:63], v10, s[8:11], s32 offen offset:1024 sc1
    v_mfma_f32_16x16x32_bf16 v[180:183], v[116:119], v[68:71], v[180:183]
    s_waitcnt lgkmcnt(8) vmcnt(12)
    v_add_u32 v20, 1, v20
    ds_write_b32 v21, v20
    s_barrier
    s_add_u32 s33, s33, 16384
    s_cmp_ge_u32 s33, 114688
    s_cselect_b32 s33, 0, s33
    v_add_u32 v2, s33, v6
    v_add_u32 v3, s33, v7
    v_add_u32 v4, s33, v8
    v_add_u32 v5, s33, v9
    v_mfma_f32_16x16x32_bf16 v[152:155], v[120:123], v[72:75], v[152:155]
    ds_read_b64_tr_b16 v[88:89], v2 offset:0
    ds_read_b64_tr_b16 v[90:91], v2 offset:2048
    v_mfma_f32_16x16x32_bf16 v[156:159], v[120:123], v[76:79], v[156:159]
    ds_read_b64_tr_b16 v[92:93], v3 offset:0
    ds_read_b64_tr_b16 v[94:95], v3 offset:2048
    v_mfma_f32_16x16x32_bf16 v[160:163], v[124:127], v[72:75], v[160:163]
    ds_read_b64_tr_b16 v[96:97], v4 offset:0
    ds_read_b64_tr_b16 v[98:99], v4 offset:2048
    v_mfma_f32_16x16x32_bf16 v[164:167], v[124:127], v[76:79], v[164:167]
    ds_read_b64_tr_b16 v[100:101], v5 offset:0
    v_mfma_f32_16x16x32_bf16 v[168:171], v[128:131], v[72:75], v[168:171]
    ds_read_b64_tr_b16 v[102:103], v5 offset:2048
    v_mfma_f32_16x16x32_bf16 v[172:175], v[128:131], v[76:79], v[172:175]
    s_add_u32 s32, s32, 8192
    buffer_load_dwordx4 v[64:67], v10, s[8:11], s32 offen sc1
    v_mfma_f32_16x16x32_bf16 v[176:179], v[132:135], v[72:75], v[176:179]
    buffer_load_dwordx4 v[68:71], v10, s[8:11], s32 offen offset:1024 sc1
    v_mfma_f32_16x16x32_bf16 v[180:183], v[132:135], v[76:79], v[180:183]
    s_waitcnt lgkmcnt(8) vmcnt(12)
    v_mfma_f32_16x16x32_bf16 v[152:155], v[136:139], v[80:83], v[152:155]
    ds_read_b64_tr_b16 v[104:105], v2 offset:8192
    ds_read_b64_tr_b16 v[106:107], v2 offset:10240
    v_mfma_f32_16x16x32_bf16 v[156:159], v[136:139], v[84:87], v[156:159]
    ds_read_b64_tr_b16 v[108:109], v3 offset:8192
    ds_read_b64_tr_b16 v[110:111], v3 offset:10240
    v_mfma_f32_16x16x32_bf16 v[160:163], v[140:143], v[80:83], v[160:163]
    ds_read_b64_tr_b16 v[112:113], v4 offset:8192
    ds_read_b64_tr_b16 v[114:115], v4 offset:10240
    v_mfma_f32_16x16x32_bf16 v[164:167], v[140:143], v[84:87], v[164:167]
    ds_read_b64_tr_b16 v[116:117], v5 offset:8192
    v_mfma_f32_16x16x32_bf16 v[168:171], v[144:147], v[80:83], v[168:171]
    ds_read_b64_tr_b16 v[118:119], v5 offset:10240
    v_mfma_f32_16x16x32_bf16 v[172:175], v[144:147], v[84:87], v[172:175]
    s_add_u32 s32, s32, 8192
    buffer_load_dwordx4 v[72:75], v10, s[8:11], s32 offen sc1
    v_mfma_f32_16x16x32_bf16 v[176:179], v[148:151], v[80:83], v[176:179]
    buffer_load_dwordx4 v[76:79], v10, s[8:11], s32 offen offset:1024 sc1
    v_mfma_f32_16x16x32_bf16 v[180:183], v[148:151], v[84:87], v[180:183]
    s_waitcnt lgkmcnt(8) vmcnt(12)
    v_mfma_f32_16x16x32_bf16 v[152:155], v[88:91], v[24:27], v[152:155]
    ds_read_b64_tr_b16 v[120:121], v2 offset:4096
    ds_read_b64_tr_b16 v[122:123], v2 offset:6144
    v_mfma_f32_16x16x32_bf16 v[156:159], v[88:91], v[28:31], v[156:159]
    ds_read_b64_tr_b16 v[124:125], v3 offset:4096
    ds_read_b64_tr_b16 v[126:127], v3 offset:6144
    v_mfma_f32_16x16x32_bf16 v[160:163], v[92:95], v[24:27], v[160:163]
    ds_read_b64_tr_b16 v[128:129], v4 offset:4096
    ds_read_b64_tr_b16 v[130:131], v4 offset:6144
    v_mfma_f32_16x16x32_bf16 v[164:167], v[92:95], v[28:31], v[164:167]
    ds_read_b64_tr_b16 v[132:133], v5 offset:4096
    v_mfma_f32_16x16x32_bf16 v[168:171], v[96:99], v[24:27], v[168:171]
    ds_read_b64_tr_b16 v[134:135], v5 offset:6144
    v_mfma_f32_16x16x32_bf16 v[172:175], v[96:99], v[28:31], v[172:175]
    s_add_u32 s32, s32, 8192
    buffer_load_dwordx4 v[80:83], v10, s[8:11], s32 offen sc1
    v_mfma_f32_16x16x32_bf16 v[176:179], v[100:103], v[24:27], v[176:179]
    buffer_load_dwordx4 v[84:87], v10, s[8:11], s32 offen offset:1024 sc1
    v_mfma_f32_16x16x32_bf16 v[180:183], v[100:103], v[28:31], v[180:183]
    s_waitcnt lgkmcnt(8) vmcnt(12)
    v_mfma_f32_16x16x32_bf16 v[152:155], v[104:107], v[32:35], v[152:155]
    ds_read_b64_tr_b16 v[136:137], v2 offset:12288
    ds_read_b64_tr_b16 v[138:139], v2 offset:14336
    v_mfma_f32_16x16x32_bf16 v[156:159], v[104:107], v[36:39], v[156:159]
    ds_read_b64_tr_b16 v[140:141], v3 offset:12288
    ds_read_b64_tr_b16 v[142:143], v3 offset:14336
    v_mfma_f32_16x16x32_bf16 v[160:163], v[108:111], v[32:35], v[160:163]
    ds_read_b64_tr_b16 v[144:145], v4 offset:12288
    ds_read_b64_tr_b16 v[146:147], v4 offset:14336
    v_mfma_f32_16x16x32_bf16 v[164:167], v[108:111], v[36:39], v[164:167]
    ds_read_b64_tr_b16 v[148:149], v5 offset:12288
    v_mfma_f32_16x16x32_bf16 v[168:171], v[112:115], v[32:35], v[168:171]
    ds_read_b64_tr_b16 v[150:151], v5 offset:14336
    v_mfma_f32_16x16x32_bf16 v[172:175], v[112:115], v[36:39], v[172:175]
    s_add_u32 s32, s32, 8192
    buffer_load_dwordx4 v[24:27], v10, s[8:11], s32 offen sc1
    v_mfma_f32_16x16x32_bf16 v[176:179], v[116:119], v[32:35], v[176:179]
    buffer_load_dwordx4 v[28:31], v10, s[8:11], s32 offen offset:1024 sc1
    v_mfma_f32_16x16x32_bf16 v[180:183], v[116:119], v[36:39], v[180:183]
    s_waitcnt lgkmcnt(8) vmcnt(12)
    v_add_u32 v20, 1, v20
    ds_write_b32 v21, v20
    s_barrier
    s_add_u32 s33, s33, 16384
    s_cmp_ge_u32 s33, 114688
    s_cselect_b32 s33, 0, s33
    v_add_u32 v2, s33, v6
    v_add_u32 v3, s33, v7
    v_add_u32 v4, s33, v8
    v_add_u32 v5, s33, v9
    v_mfma_f32_16x16x32_bf16 v[152:155], v[120:123], v[40:43], v[152:155]
    ds_read_b64_tr_b16 v[88:89], v2 offset:0
    ds_read_b64_tr_b16 v[90:91], v2 offset:2048
    v_mfma_f32_16x16x32_bf16 v[156:159], v[120:123], v[44:47], v[156:159]
    ds_read_b64_tr_b16 v[92:93], v3 offset:0
    ds_read_b64_tr_b16 v[94:95], v3 offset:2048
    v_mfma_f32_16x16x32_bf16 v[160:163], v[124:127], v[40:43], v[160:163]
    ds_read_b64_tr_b16 v[96:97], v4 offset:0
    ds_read_b64_tr_b16 v[98:99], v4 offset:2048
    v_mfma_f32_16x16x32_bf16 v[164:167], v[124:127], v[44:47], v[164:167]
    ds_read_b64_tr_b16 v[100:101], v5 offset:0
    v_mfma_f32_16x16x32_bf16 v[168:171], v[128:131], v[40:43], v[168:171]
    ds_read_b64_tr_b16 v[102:103], v5 offset:2048
    v_mfma_f32_16x16x32_bf16 v[172:175], v[128:131], v[44:47], v[172:175]
    s_add_u32 s32, s32, 8192
    buffer_load_dwordx4 v[32:35], v10, s[8:11], s32 offen sc1
    v_mfma_f32_16x16x32_bf16 v[176:179], v[132:135], v[40:43], v[176:179]
    buffer_load_dwordx4 v[36:39], v10, s[8:11], s32 offen offset:1024 sc1
    v_mfma_f32_16x16x32_bf16 v[180:183], v[132:135], v[44:47], v[180:183]
    s_waitcnt lgkmcnt(8) vmcnt(12)
    v_mfma_f32_16x16x32_bf16 v[152:155], v[136:139], v[48:51], v[152:155]
    ds_read_b64_tr_b16 v[104:105], v2 offset:8192
    ds_read_b64_tr_b16 v[106:107], v2 offset:10240
    v_mfma_f32_16x16x32_bf16 v[156:159], v[136:139], v[52:55], v[156:159]
    ds_read_b64_tr_b16 v[108:109], v3 offset:8192
    ds_read_b64_tr_b16 v[110:111], v3 offset:10240
    v_mfma_f32_16x16x32_bf16 v[160:163], v[140:143], v[48:51], v[160:163]
    ds_read_b64_tr_b16 v[112:113], v4 offset:8192
    ds_read_b64_tr_b16 v[114:115], v4 offset:10240
    v_mfma_f32_16x16x32_bf16 v[164:167], v[140:143], v[52:55], v[164:167]
    ds_read_b64_tr_b16 v[116:117], v5 offset:8192
    v_mfma_f32_16x16x32_bf16 v[168:171], v[144:147], v[48:51], v[168:171]
    ds_read_b64_tr_b16 v[118:119], v5 offset:10240
    v_mfma_f32_16x16x32_bf16 v[172:175], v[144:147], v[52:55], v[172:175]
    s_add_u32 s32, s32, 8192
    buffer_load_dwordx4 v[40:43], v10, s[8:11], s32 offen sc1
    v_mfma_f32_16x16x32_bf16 v[176:179], v[148:151], v[48:51], v[176:179]
    buffer_load_dwordx4 v[44:47], v10, s[8:11], s32 offen offset:1024 sc1
    v_mfma_f32_16x16x32_bf16 v[180:183], v[148:151], v[52:55], v[180:183]
    s_waitcnt lgkmcnt(8) vmcnt(12)
    v_mfma_f32_16x16x32_bf16 v[152:155], v[88:91], v[56:59], v[152:155]
    ds_read_b64_tr_b16 v[120:121], v2 offset:4096
    ds_read_b64_tr_b16 v[122:123], v2 offset:6144
    v_mfma_f32_16x16x32_bf16 v[156:159], v[88:91], v[60:63], v[156:159]
    ds_read_b64_tr_b16 v[124:125], v3 offset:4096
    ds_read_b64_tr_b16 v[126:127], v3 offset:6144
    v_mfma_f32_16x16x32_bf16 v[160:163], v[92:95], v[56:59], v[160:163]
    ds_read_b64_tr_b16 v[128:129], v4 offset:4096
    ds_read_b64_tr_b16 v[130:131], v4 offset:6144
    v_mfma_f32_16x16x32_bf16 v[164:167], v[92:95], v[60:63], v[164:167]
    ds_read_b64_tr_b16 v[132:133], v5 offset:4096
    v_mfma_f32_16x16x32_bf16 v[168:171], v[96:99], v[56:59], v[168:171]
    ds_read_b64_tr_b16 v[134:135], v5 offset:6144
    v_mfma_f32_16x16x32_bf16 v[172:175], v[96:99], v[60:63], v[172:175]
    s_add_u32 s32, s32, 8192
    buffer_load_dwordx4 v[48:51], v10, s[8:11], s32 offen sc1
    v_mfma_f32_16x16x32_bf16 v[176:179], v[100:103], v[56:59], v[176:179]
    buffer_load_dwordx4 v[52:55], v10, s[8:11], s32 offen offset:1024 sc1
    v_mfma_f32_16x16x32_bf16 v[180:183], v[100:103], v[60:63], v[180:183]
    s_waitcnt lgkmcnt(8) vmcnt(12)
    v_mfma_f32_16x16x32_bf16 v[152:155], v[104:107], v[64:67], v[152:155]
    ds_read_b64_tr_b16 v[136:137], v2 offset:12288
    ds_read_b64_tr_b16 v[138:139], v2 offset:14336
    v_mfma_f32_16x16x32_bf16 v[156:159], v[104:107], v[68:71], v[156:159]
    ds_read_b64_tr_b16 v[140:141], v3 offset:12288
    ds_read_b64_tr_b16 v[142:143], v3 offset:14336
    v_mfma_f32_16x16x32_bf16 v[160:163], v[108:111], v[64:67], v[160:163]
    ds_read_b64_tr_b16 v[144:145], v4 offset:12288
    ds_read_b64_tr_b16 v[146:147], v4 offset:14336
    v_mfma_f32_16x16x32_bf16 v[164:167], v[108:111], v[68:71], v[164:167]
    ds_read_b64_tr_b16 v[148:149], v5 offset:12288
    v_mfma_f32_16x16x32_bf16 v[168:171], v[112:115], v[64:67], v[168:171]
    ds_read_b64_tr_b16 v[150:151], v5 offset:14336
    v_mfma_f32_16x16x32_bf16 v[172:175], v[112:115], v[68:71], v[172:175]
    s_add_u32 s32, s32, 8192
    buffer_load_dwordx4 v[56:59], v10, s[8:11], s32 offen sc1
    v_mfma_f32_16x16x32_bf16 v[176:179], v[116:119], v[64:67], v[176:179]
    buffer_load_dwordx4 v[60:63], v10, s[8:11], s32 offen offset:1024 sc1
    v_mfma_f32_16x16x32_bf16 v[180:183], v[116:119], v[68:71], v[180:183]
    s_waitcnt lgkmcnt(8) vmcnt(12)
    v_add_u32 v20, 1, v20
    ds_write_b32 v21, v20
    s_barrier
    s_add_u32 s33, s33, 16384
    s_cmp_ge_u32 s33, 114688
    s_cselect_b32 s33, 0, s33
    v_add_u32 v2, s33, v6
    v_add_u32 v3, s33, v7
    v_add_u32 v4, s33, v8
    v_add_u32 v5, s33, v9
    v_mfma_f32_16x16x32_bf16 v[152:155], v[120:123], v[72:75], v[152:155]
    ds_read_b64_tr_b16 v[88:89], v2 offset:0
    ds_read_b64_tr_b16 v[90:91], v2 offset:2048
    v_mfma_f32_16x16x32_bf16 v[156:159], v[120:123], v[76:79], v[156:159]
    ds_read_b64_tr_b16 v[92:93], v3 offset:0
    ds_read_b64_tr_b16 v[94:95], v3 offset:2048
    v_mfma_f32_16x16x32_bf16 v[160:163], v[124:127], v[72:75], v[160:163]
    ds_read_b64_tr_b16 v[96:97], v4 offset:0
    ds_read_b64_tr_b16 v[98:99], v4 offset:2048
    v_mfma_f32_16x16x32_bf16 v[164:167], v[124:127], v[76:79], v[164:167]
    ds_read_b64_tr_b16 v[100:101], v5 offset:0
    v_mfma_f32_16x16x32_bf16 v[168:171], v[128:131], v[72:75], v[168:171]
    ds_read_b64_tr_b16 v[102:103], v5 offset:2048
    v_mfma_f32_16x16x32_bf16 v[172:175], v[128:131], v[76:79], v[172:175]
    s_add_u32 s32, s32, 8192
    buffer_load_dwordx4 v[64:67], v10, s[8:11], s32 offen sc1
    v_mfma_f32_16x16x32_bf16 v[176:179], v[132:135], v[72:75], v[176:179]
    buffer_load_dwordx4 v[68:71], v10, s[8:11], s32 offen offset:1024 sc1
    v_mfma_f32_16x16x32_bf16 v[180:183], v[132:135], v[76:79], v[180:183]
    s_waitcnt lgkmcnt(8) vmcnt(12)
    v_mfma_f32_16x16x32_bf16 v[152:155], v[136:139], v[80:83], v[152:155]
    ds_read_b64_tr_b16 v[104:105], v2 offset:8192
    ds_read_b64_tr_b16 v[106:107], v2 offset:10240
    v_mfma_f32_16x16x32_bf16 v[156:159], v[136:139], v[84:87], v[156:159]
    ds_read_b64_tr_b16 v[108:109], v3 offset:8192
    ds_read_b64_tr_b16 v[110:111], v3 offset:10240
    v_mfma_f32_16x16x32_bf16 v[160:163], v[140:143], v[80:83], v[160:163]
    ds_read_b64_tr_b16 v[112:113], v4 offset:8192
    ds_read_b64_tr_b16 v[114:115], v4 offset:10240
    v_mfma_f32_16x16x32_bf16 v[164:167], v[140:143], v[84:87], v[164:167]
    ds_read_b64_tr_b16 v[116:117], v5 offset:8192
    v_mfma_f32_16x16x32_bf16 v[168:171], v[144:147], v[80:83], v[168:171]
    ds_read_b64_tr_b16 v[118:119], v5 offset:10240
    v_mfma_f32_16x16x32_bf16 v[172:175], v[144:147], v[84:87], v[172:175]
    s_add_u32 s32, s32, 8192
    buffer_load_dwordx4 v[72:75], v10, s[8:11], s32 offen sc1
    v_mfma_f32_16x16x32_bf16 v[176:179], v[148:151], v[80:83], v[176:179]
    buffer_load_dwordx4 v[76:79], v10, s[8:11], s32 offen offset:1024 sc1
    v_mfma_f32_16x16x32_bf16 v[180:183], v[148:151], v[84:87], v[180:183]
    s_waitcnt lgkmcnt(8) vmcnt(12)
    v_mfma_f32_16x16x32_bf16 v[152:155], v[88:91], v[24:27], v[152:155]
    ds_read_b64_tr_b16 v[120:121], v2 offset:4096
    ds_read_b64_tr_b16 v[122:123], v2 offset:6144
    v_mfma_f32_16x16x32_bf16 v[156:159], v[88:91], v[28:31], v[156:159]
    ds_read_b64_tr_b16 v[124:125], v3 offset:4096
    ds_read_b64_tr_b16 v[126:127], v3 offset:6144
    v_mfma_f32_16x16x32_bf16 v[160:163], v[92:95], v[24:27], v[160:163]
    ds_read_b64_tr_b16 v[128:129], v4 offset:4096
    ds_read_b64_tr_b16 v[130:131], v4 offset:6144
    v_mfma_f32_16x16x32_bf16 v[164:167], v[92:95], v[28:31], v[164:167]
    ds_read_b64_tr_b16 v[132:133], v5 offset:4096
    v_mfma_f32_16x16x32_bf16 v[168:171], v[96:99], v[24:27], v[168:171]
    ds_read_b64_tr_b16 v[134:135], v5 offset:6144
    v_mfma_f32_16x16x32_bf16 v[172:175], v[96:99], v[28:31], v[172:175]
    s_add_u32 s32, s32, 8192
    buffer_load_dwordx4 v[80:83], v10, s[8:11], s32 offen sc1
    v_mfma_f32_16x16x32_bf16 v[176:179], v[100:103], v[24:27], v[176:179]
    buffer_load_dwordx4 v[84:87], v10, s[8:11], s32 offen offset:1024 sc1
    v_mfma_f32_16x16x32_bf16 v[180:183], v[100:103], v[28:31], v[180:183]
    s_waitcnt lgkmcnt(8) vmcnt(12)
    v_mfma_f32_16x16x32_bf16 v[152:155], v[104:107], v[32:35], v[152:155]
    ds_read_b64_tr_b16 v[136:137], v2 offset:12288
    ds_read_b64_tr_b16 v[138:139], v2 offset:14336
    v_mfma_f32_16x16x32_bf16 v[156:159], v[104:107], v[36:39], v[156:159]
    ds_read_b64_tr_b16 v[140:141], v3 offset:12288
    ds_read_b64_tr_b16 v[142:143], v3 offset:14336
    v_mfma_f32_16x16x32_bf16 v[160:163], v[108:111], v[32:35], v[160:163]
    ds_read_b64_tr_b16 v[144:145], v4 offset:12288
    ds_read_b64_tr_b16 v[146:147], v4 offset:14336
    v_mfma_f32_16x16x32_bf16 v[164:167], v[108:111], v[36:39], v[164:167]
    ds_read_b64_tr_b16 v[148:149], v5 offset:12288
    v_mfma_f32_16x16x32_bf16 v[168:171], v[112:115], v[32:35], v[168:171]
    ds_read_b64_tr_b16 v[150:151], v5 offset:14336
    v_mfma_f32_16x16x32_bf16 v[172:175], v[112:115], v[36:39], v[172:175]
    s_add_u32 s32, s32, 8192
    buffer_load_dwordx4 v[24:27], v10, s[8:11], s32 offen sc1
    v_mfma_f32_16x16x32_bf16 v[176:179], v[116:119], v[32:35], v[176:179]
    buffer_load_dwordx4 v[28:31], v10, s[8:11], s32 offen offset:1024 sc1
    v_mfma_f32_16x16x32_bf16 v[180:183], v[116:119], v[36:39], v[180:183]
    s_waitcnt lgkmcnt(8) vmcnt(12)
    v_add_u32 v20, 1, v20
    ds_write_b32 v21, v20
    s_barrier
    s_add_u32 s33, s33, 16384
    s_cmp_ge_u32 s33, 114688
    s_cselect_b32 s33, 0, s33
    v_add_u32 v2, s33, v6
    v_add_u32 v3, s33, v7
    v_add_u32 v4, s33, v8
    v_add_u32 v5, s33, v9
    v_mfma_f32_16x16x32_bf16 v[152:155], v[120:123], v[40:43], v[152:155]
    ds_read_b64_tr_b16 v[88:89], v2 offset:0
    ds_read_b64_tr_b16 v[90:91], v2 offset:2048
    v_mfma_f32_16x16x32_bf16 v[156:159], v[120:123], v[44:47], v[156:159]
    ds_read_b64_tr_b16 v[92:93], v3 offset:0
    ds_read_b64_tr_b16 v[94:95], v3 offset:2048
    v_mfma_f32_16x16x32_bf16 v[160:163], v[124:127], v[40:43], v[160:163]
    ds_read_b64_tr_b16 v[96:97], v4 offset:0
    ds_read_b64_tr_b16 v[98:99], v4 offset:2048
    v_mfma_f32_16x16x32_bf16 v[164:167], v[124:127], v[44:47], v[164:167]
    ds_read_b64_tr_b16 v[100:101], v5 offset:0
    v_mfma_f32_16x16x32_bf16 v[168:171], v[128:131], v[40:43], v[168:171]
    ds_read_b64_tr_b16 v[102:103], v5 offset:2048
    v_mfma_f32_16x16x32_bf16 v[172:175], v[128:131], v[44:47], v[172:175]
    s_add_u32 s32, s32, 8192
    buffer_load_dwordx4 v[32:35], v10, s[8:11], s32 offen sc1
    v_mfma_f32_16x16x32_bf16 v[176:179], v[132:135], v[40:43], v[176:179]
    buffer_load_dwordx4 v[36:39], v10, s[8:11], s32 offen offset:1024 sc1
    v_mfma_f32_16x16x32_bf16 v[180:183], v[132:135], v[44:47], v[180:183]
    s_waitcnt lgkmcnt(8) vmcnt(12)
    v_mfma_f32_16x16x32_bf16 v[152:155], v[136:139], v[48:51], v[152:155]
    ds_read_b64_tr_b16 v[104:105], v2 offset:8192
    ds_read_b64_tr_b16 v[106:107], v2 offset:10240
    v_mfma_f32_16x16x32_bf16 v[156:159], v[136:139], v[52:55], v[156:159]
    ds_read_b64_tr_b16 v[108:109], v3 offset:8192
    ds_read_b64_tr_b16 v[110:111], v3 offset:10240
    v_mfma_f32_16x16x32_bf16 v[160:163], v[140:143], v[48:51], v[160:163]
    ds_read_b64_tr_b16 v[112:113], v4 offset:8192
    ds_read_b64_tr_b16 v[114:115], v4 offset:10240
    v_mfma_f32_16x16x32_bf16 v[164:167], v[140:143], v[52:55], v[164:167]
    ds_read_b64_tr_b16 v[116:117], v5 offset:8192
    v_mfma_f32_16x16x32_bf16 v[168:171], v[144:147], v[48:51], v[168:171]
    ds_read_b64_tr_b16 v[118:119], v5 offset:10240
    v_mfma_f32_16x16x32_bf16 v[172:175], v[144:147], v[52:55], v[172:175]
    s_add_u32 s32, s32, 8192
    buffer_load_dwordx4 v[40:43], v10, s[8:11], s32 offen sc1
    v_mfma_f32_16x16x32_bf16 v[176:179], v[148:151], v[48:51], v[176:179]
    buffer_load_dwordx4 v[44:47], v10, s[8:11], s32 offen offset:1024 sc1
    v_mfma_f32_16x16x32_bf16 v[180:183], v[148:151], v[52:55], v[180:183]
    s_waitcnt lgkmcnt(8) vmcnt(12)
    v_mfma_f32_16x16x32_bf16 v[152:155], v[88:91], v[56:59], v[152:155]
    ds_read_b64_tr_b16 v[120:121], v2 offset:4096
    ds_read_b64_tr_b16 v[122:123], v2 offset:6144
    v_mfma_f32_16x16x32_bf16 v[156:159], v[88:91], v[60:63], v[156:159]
    ds_read_b64_tr_b16 v[124:125], v3 offset:4096
    ds_read_b64_tr_b16 v[126:127], v3 offset:6144
    v_mfma_f32_16x16x32_bf16 v[160:163], v[92:95], v[56:59], v[160:163]
    ds_read_b64_tr_b16 v[128:129], v4 offset:4096
    ds_read_b64_tr_b16 v[130:131], v4 offset:6144
    v_mfma_f32_16x16x32_bf16 v[164:167], v[92:95], v[60:63], v[164:167]
    ds_read_b64_tr_b16 v[132:133], v5 offset:4096
    v_mfma_f32_16x16x32_bf16 v[168:171], v[96:99], v[56:59], v[168:171]
    ds_read_b64_tr_b16 v[134:135], v5 offset:6144
    v_mfma_f32_16x16x32_bf16 v[172:175], v[96:99], v[60:63], v[172:175]
    s_add_u32 s32, s32, 8192
    buffer_load_dwordx4 v[48:51], v10, s[8:11], s32 offen sc1
    v_mfma_f32_16x16x32_bf16 v[176:179], v[100:103], v[56:59], v[176:179]
    buffer_load_dwordx4 v[52:55], v10, s[8:11], s32 offen offset:1024 sc1
    v_mfma_f32_16x16x32_bf16 v[180:183], v[100:103], v[60:63], v[180:183]
    s_waitcnt lgkmcnt(8) vmcnt(12)
    v_mfma_f32_16x16x32_bf16 v[152:155], v[104:107], v[64:67], v[152:155]
    ds_read_b64_tr_b16 v[136:137], v2 offset:12288
    ds_read_b64_tr_b16 v[138:139], v2 offset:14336
    v_mfma_f32_16x16x32_bf16 v[156:159], v[104:107], v[68:71], v[156:159]
    ds_read_b64_tr_b16 v[140:141], v3 offset:12288
    ds_read_b64_tr_b16 v[142:143], v3 offset:14336
    v_mfma_f32_16x16x32_bf16 v[160:163], v[108:111], v[64:67], v[160:163]
    ds_read_b64_tr_b16 v[144:145], v4 offset:12288
    ds_read_b64_tr_b16 v[146:147], v4 offset:14336
    v_mfma_f32_16x16x32_bf16 v[164:167], v[108:111], v[68:71], v[164:167]
    ds_read_b64_tr_b16 v[148:149], v5 offset:12288
    v_mfma_f32_16x16x32_bf16 v[168:171], v[112:115], v[64:67], v[168:171]
    ds_read_b64_tr_b16 v[150:151], v5 offset:14336
    v_mfma_f32_16x16x32_bf16 v[172:175], v[112:115], v[68:71], v[172:175]
    s_add_u32 s32, s32, 8192
    buffer_load_dwordx4 v[56:59], v10, s[8:11], s32 offen sc1
    v_mfma_f32_16x16x32_bf16 v[176:179], v[116:119], v[64:67], v[176:179]
    buffer_load_dwordx4 v[60:63], v10, s[8:11], s32 offen offset:1024 sc1
    v_mfma_f32_16x16x32_bf16 v[180:183], v[116:119], v[68:71], v[180:183]
    s_waitcnt lgkmcnt(8) vmcnt(12)
    v_add_u32 v20, 1, v20
    ds_write_b32 v21, v20
    s_barrier
    s_add_u32 s33, s33, 16384
    s_cmp_ge_u32 s33, 114688
    s_cselect_b32 s33, 0, s33
    v_add_u32 v2, s33, v6
    v_add_u32 v3, s33, v7
    v_add_u32 v4, s33, v8
    v_add_u32 v5, s33, v9
    v_mfma_f32_16x16x32_bf16 v[152:155], v[120:123], v[72:75], v[152:155]
    ds_read_b64_tr_b16 v[88:89], v2 offset:0
    ds_read_b64_tr_b16 v[90:91], v2 offset:2048
    v_mfma_f32_16x16x32_bf16 v[156:159], v[120:123], v[76:79], v[156:159]
    ds_read_b64_tr_b16 v[92:93], v3 offset:0
    ds_read_b64_tr_b16 v[94:95], v3 offset:2048
    v_mfma_f32_16x16x32_bf16 v[160:163], v[124:127], v[72:75], v[160:163]
    ds_read_b64_tr_b16 v[96:97], v4 offset:0
    ds_read_b64_tr_b16 v[98:99], v4 offset:2048
    v_mfma_f32_16x16x32_bf16 v[164:167], v[124:127], v[76:79], v[164:167]
    ds_read_b64_tr_b16 v[100:101], v5 offset:0
    v_mfma_f32_16x16x32_bf16 v[168:171], v[128:131], v[72:75], v[168:171]
    ds_read_b64_tr_b16 v[102:103], v5 offset:2048
    v_mfma_f32_16x16x32_bf16 v[172:175], v[128:131], v[76:79], v[172:175]
    s_add_u32 s32, s32, 8192
    buffer_load_dwordx4 v[64:67], v10, s[8:11], s32 offen sc1
    v_mfma_f32_16x16x32_bf16 v[176:179], v[132:135], v[72:75], v[176:179]
    buffer_load_dwordx4 v[68:71], v10, s[8:11], s32 offen offset:1024 sc1
    v_mfma_f32_16x16x32_bf16 v[180:183], v[132:135], v[76:79], v[180:183]
    s_waitcnt lgkmcnt(8) vmcnt(12)
    v_mfma_f32_16x16x32_bf16 v[152:155], v[136:139], v[80:83], v[152:155]
    ds_read_b64_tr_b16 v[104:105], v2 offset:8192
    ds_read_b64_tr_b16 v[106:107], v2 offset:10240
    v_mfma_f32_16x16x32_bf16 v[156:159], v[136:139], v[84:87], v[156:159]
    ds_read_b64_tr_b16 v[108:109], v3 offset:8192
    ds_read_b64_tr_b16 v[110:111], v3 offset:10240
    v_mfma_f32_16x16x32_bf16 v[160:163], v[140:143], v[80:83], v[160:163]
    ds_read_b64_tr_b16 v[112:113], v4 offset:8192
    ds_read_b64_tr_b16 v[114:115], v4 offset:10240
    v_mfma_f32_16x16x32_bf16 v[164:167], v[140:143], v[84:87], v[164:167]
    ds_read_b64_tr_b16 v[116:117], v5 offset:8192
    v_mfma_f32_16x16x32_bf16 v[168:171], v[144:147], v[80:83], v[168:171]
    ds_read_b64_tr_b16 v[118:119], v5 offset:10240
    v_mfma_f32_16x16x32_bf16 v[172:175], v[144:147], v[84:87], v[172:175]
    s_add_u32 s32, s32, 8192
    buffer_load_dwordx4 v[72:75], v10, s[8:11], s32 offen sc1
    v_mfma_f32_16x16x32_bf16 v[176:179], v[148:151], v[80:83], v[176:179]
    buffer_load_dwordx4 v[76:79], v10, s[8:11], s32 offen offset:1024 sc1
    v_mfma_f32_16x16x32_bf16 v[180:183], v[148:151], v[84:87], v[180:183]
    s_waitcnt lgkmcnt(8) vmcnt(12)
    v_mfma_f32_16x16x32_bf16 v[152:155], v[88:91], v[24:27], v[152:155]
    ds_read_b64_tr_b16 v[120:121], v2 offset:4096
    ds_read_b64_tr_b16 v[122:123], v2 offset:6144
    v_mfma_f32_16x16x32_bf16 v[156:159], v[88:91], v[28:31], v[156:159]
    ds_read_b64_tr_b16 v[124:125], v3 offset:4096
    ds_read_b64_tr_b16 v[126:127], v3 offset:6144
    v_mfma_f32_16x16x32_bf16 v[160:163], v[92:95], v[24:27], v[160:163]
    ds_read_b64_tr_b16 v[128:129], v4 offset:4096
    ds_read_b64_tr_b16 v[130:131], v4 offset:6144
    v_mfma_f32_16x16x32_bf16 v[164:167], v[92:95], v[28:31], v[164:167]
    ds_read_b64_tr_b16 v[132:133], v5 offset:4096
    v_mfma_f32_16x16x32_bf16 v[168:171], v[96:99], v[24:27], v[168:171]
    ds_read_b64_tr_b16 v[134:135], v5 offset:6144
    v_mfma_f32_16x16x32_bf16 v[172:175], v[96:99], v[28:31], v[172:175]
    s_add_u32 s32, s32, 8192
    buffer_load_dwordx4 v[80:83], v10, s[8:11], s32 offen sc1
    v_mfma_f32_16x16x32_bf16 v[176:179], v[100:103], v[24:27], v[176:179]
    buffer_load_dwordx4 v[84:87], v10, s[8:11], s32 offen offset:1024 sc1
    v_mfma_f32_16x16x32_bf16 v[180:183], v[100:103], v[28:31], v[180:183]
    s_waitcnt lgkmcnt(8) vmcnt(12)
    v_mfma_f32_16x16x32_bf16 v[152:155], v[104:107], v[32:35], v[152:155]
    ds_read_b64_tr_b16 v[136:137], v2 offset:12288
    ds_read_b64_tr_b16 v[138:139], v2 offset:14336
    v_mfma_f32_16x16x32_bf16 v[156:159], v[104:107], v[36:39], v[156:159]
    ds_read_b64_tr_b16 v[140:141], v3 offset:12288
    v_mfma_f32_16x16x32_bf16 v[160:163], v[108:111], v[32:35], v[160:163]
    ds_read_b64_tr_b16 v[142:143], v3 offset:14336
    v_mfma_f32_16x16x32_bf16 v[164:167], v[108:111], v[36:39], v[164:167]
    ds_read_b64_tr_b16 v[144:145], v4 offset:12288
    v_mfma_f32_16x16x32_bf16 v[168:171], v[112:115], v[32:35], v[168:171]
    ds_read_b64_tr_b16 v[146:147], v4 offset:14336
    v_mfma_f32_16x16x32_bf16 v[172:175], v[112:115], v[36:39], v[172:175]
    ds_read_b64_tr_b16 v[148:149], v5 offset:12288
    v_mfma_f32_16x16x32_bf16 v[176:179], v[116:119], v[32:35], v[176:179]
    ds_read_b64_tr_b16 v[150:151], v5 offset:14336
    v_mfma_f32_16x16x32_bf16 v[180:183], v[116:119], v[36:39], v[180:183]
    s_waitcnt lgkmcnt(8) vmcnt(10)
    v_add_u32 v20, 1, v20
    ds_write_b32 v21, v20
    s_barrier
    s_add_u32 s33, s33, 16384
    s_cmp_ge_u32 s33, 114688
    s_cselect_b32 s33, 0, s33
    v_add_u32 v2, s33, v6
    v_add_u32 v3, s33, v7
    v_add_u32 v4, s33, v8
    v_add_u32 v5, s33, v9
    v_mfma_f32_16x16x32_bf16 v[152:155], v[120:123], v[40:43], v[152:155]
    ds_read_b64_tr_b16 v[88:89], v2 offset:0
    ds_read_b64_tr_b16 v[90:91], v2 offset:2048
    v_mfma_f32_16x16x32_bf16 v[156:159], v[120:123], v[44:47], v[156:159]
    ds_read_b64_tr_b16 v[92:93], v3 offset:0
    v_mfma_f32_16x16x32_bf16 v[160:163], v[124:127], v[40:43], v[160:163]
    ds_read_b64_tr_b16 v[94:95], v3 offset:2048
    v_mfma_f32_16x16x32_bf16 v[164:167], v[124:127], v[44:47], v[164:167]
    ds_read_b64_tr_b16 v[96:97], v4 offset:0
    v_mfma_f32_16x16x32_bf16 v[168:171], v[128:131], v[40:43], v[168:171]
    ds_read_b64_tr_b16 v[98:99], v4 offset:2048
    v_mfma_f32_16x16x32_bf16 v[172:175], v[128:131], v[44:47], v[172:175]
    ds_read_b64_tr_b16 v[100:101], v5 offset:0
    v_mfma_f32_16x16x32_bf16 v[176:179], v[132:135], v[40:43], v[176:179]
    ds_read_b64_tr_b16 v[102:103], v5 offset:2048
    v_mfma_f32_16x16x32_bf16 v[180:183], v[132:135], v[44:47], v[180:183]
    s_waitcnt lgkmcnt(8) vmcnt(8)
    v_mfma_f32_16x16x32_bf16 v[152:155], v[136:139], v[48:51], v[152:155]
    ds_read_b64_tr_b16 v[104:105], v2 offset:8192
    ds_read_b64_tr_b16 v[106:107], v2 offset:10240
    v_mfma_f32_16x16x32_bf16 v[156:159], v[136:139], v[52:55], v[156:159]
    ds_read_b64_tr_b16 v[108:109], v3 offset:8192
    v_mfma_f32_16x16x32_bf16 v[160:163], v[140:143], v[48:51], v[160:163]
    ds_read_b64_tr_b16 v[110:111], v3 offset:10240
    v_mfma_f32_16x16x32_bf16 v[164:167], v[140:143], v[52:55], v[164:167]
    ds_read_b64_tr_b16 v[112:113], v4 offset:8192
    v_mfma_f32_16x16x32_bf16 v[168:171], v[144:147], v[48:51], v[168:171]
    ds_read_b64_tr_b16 v[114:115], v4 offset:10240
    v_mfma_f32_16x16x32_bf16 v[172:175], v[144:147], v[52:55], v[172:175]
    ds_read_b64_tr_b16 v[116:117], v5 offset:8192
    v_mfma_f32_16x16x32_bf16 v[176:179], v[148:151], v[48:51], v[176:179]
    ds_read_b64_tr_b16 v[118:119], v5 offset:10240
    v_mfma_f32_16x16x32_bf16 v[180:183], v[148:151], v[52:55], v[180:183]
    s_waitcnt lgkmcnt(8) vmcnt(6)
    v_mfma_f32_16x16x32_bf16 v[152:155], v[88:91], v[56:59], v[152:155]
    ds_read_b64_tr_b16 v[120:121], v2 offset:4096
    ds_read_b64_tr_b16 v[122:123], v2 offset:6144
    v_mfma_f32_16x16x32_bf16 v[156:159], v[88:91], v[60:63], v[156:159]
    ds_read_b64_tr_b16 v[124:125], v3 offset:4096
    v_mfma_f32_16x16x32_bf16 v[160:163], v[92:95], v[56:59], v[160:163]
    ds_read_b64_tr_b16 v[126:127], v3 offset:6144
    v_mfma_f32_16x16x32_bf16 v[164:167], v[92:95], v[60:63], v[164:167]
    ds_read_b64_tr_b16 v[128:129], v4 offset:4096
    v_mfma_f32_16x16x32_bf16 v[168:171], v[96:99], v[56:59], v[168:171]
    ds_read_b64_tr_b16 v[130:131], v4 offset:6144
    v_mfma_f32_16x16x32_bf16 v[172:175], v[96:99], v[60:63], v[172:175]
    ds_read_b64_tr_b16 v[132:133], v5 offset:4096
    v_mfma_f32_16x16x32_bf16 v[176:179], v[100:103], v[56:59], v[176:179]
    ds_read_b64_tr_b16 v[134:135], v5 offset:6144
    v_mfma_f32_16x16x32_bf16 v[180:183], v[100:103], v[60:63], v[180:183]
    s_waitcnt lgkmcnt(8) vmcnt(4)
    v_mfma_f32_16x16x32_bf16 v[152:155], v[104:107], v[64:67], v[152:155]
    ds_read_b64_tr_b16 v[136:137], v2 offset:12288
    ds_read_b64_tr_b16 v[138:139], v2 offset:14336
    v_mfma_f32_16x16x32_bf16 v[156:159], v[104:107], v[68:71], v[156:159]
    ds_read_b64_tr_b16 v[140:141], v3 offset:12288
    v_mfma_f32_16x16x32_bf16 v[160:163], v[108:111], v[64:67], v[160:163]
    ds_read_b64_tr_b16 v[142:143], v3 offset:14336
    v_mfma_f32_16x16x32_bf16 v[164:167], v[108:111], v[68:71], v[164:167]
    ds_read_b64_tr_b16 v[144:145], v4 offset:12288
    v_mfma_f32_16x16x32_bf16 v[168:171], v[112:115], v[64:67], v[168:171]
    ds_read_b64_tr_b16 v[146:147], v4 offset:14336
    v_mfma_f32_16x16x32_bf16 v[172:175], v[112:115], v[68:71], v[172:175]
    ds_read_b64_tr_b16 v[148:149], v5 offset:12288
    v_mfma_f32_16x16x32_bf16 v[176:179], v[116:119], v[64:67], v[176:179]
    ds_read_b64_tr_b16 v[150:151], v5 offset:14336
    v_mfma_f32_16x16x32_bf16 v[180:183], v[116:119], v[68:71], v[180:183]
    s_waitcnt lgkmcnt(8) vmcnt(2)
    v_mfma_f32_16x16x32_bf16 v[152:155], v[120:123], v[72:75], v[152:155]
    v_mfma_f32_16x16x32_bf16 v[156:159], v[120:123], v[76:79], v[156:159]
    v_mfma_f32_16x16x32_bf16 v[160:163], v[124:127], v[72:75], v[160:163]
    v_mfma_f32_16x16x32_bf16 v[164:167], v[124:127], v[76:79], v[164:167]
    v_mfma_f32_16x16x32_bf16 v[168:171], v[128:131], v[72:75], v[168:171]
    v_mfma_f32_16x16x32_bf16 v[172:175], v[128:131], v[76:79], v[172:175]
    v_mfma_f32_16x16x32_bf16 v[176:179], v[132:135], v[72:75], v[176:179]
    v_mfma_f32_16x16x32_bf16 v[180:183], v[132:135], v[76:79], v[180:183]
    s_waitcnt lgkmcnt(0) vmcnt(0)
    v_mfma_f32_16x16x32_bf16 v[152:155], v[136:139], v[80:83], v[152:155]
    v_mfma_f32_16x16x32_bf16 v[156:159], v[136:139], v[84:87], v[156:159]
    v_mfma_f32_16x16x32_bf16 v[160:163], v[140:143], v[80:83], v[160:163]
    v_mfma_f32_16x16x32_bf16 v[164:167], v[140:143], v[84:87], v[164:167]
    v_mfma_f32_16x16x32_bf16 v[168:171], v[144:147], v[80:83], v[168:171]
    v_mfma_f32_16x16x32_bf16 v[172:175], v[144:147], v[84:87], v[172:175]
    v_mfma_f32_16x16x32_bf16 v[176:179], v[148:151], v[80:83], v[176:179]
    v_mfma_f32_16x16x32_bf16 v[180:183], v[148:151], v[84:87], v[180:183]
    s_barrier
    ds_read_b128 v[184:187], v12 offset:0
    ds_read_b128 v[188:191], v12 offset:1024
    ds_read_b128 v[192:195], v12 offset:2048
    ds_read_b128 v[196:199], v12 offset:3072
    ds_read_b128 v[200:203], v12 offset:4096
    ds_read_b128 v[204:207], v12 offset:5120
    ds_read_b128 v[208:211], v12 offset:6144
    ds_read_b128 v[212:215], v12 offset:7168
    s_waitcnt lgkmcnt(0)
    v_add_f32 v152, v152, v184
    v_add_f32 v153, v153, v185
    v_add_f32 v154, v154, v186
    v_add_f32 v155, v155, v187
    v_add_f32 v156, v156, v188
    v_add_f32 v157, v157, v189
    v_add_f32 v158, v158, v190
    v_add_f32 v159, v159, v191
    v_add_f32 v160, v160, v192
    v_add_f32 v161, v161, v193
    v_add_f32 v162, v162, v194
    v_add_f32 v163, v163, v195
    v_add_f32 v164, v164, v196
    v_add_f32 v165, v165, v197
    v_add_f32 v166, v166, v198
    v_add_f32 v167, v167, v199
    v_add_f32 v168, v168, v200
    v_add_f32 v169, v169, v201
    v_add_f32 v170, v170, v202
    v_add_f32 v171, v171, v203
    v_add_f32 v172, v172, v204
    v_add_f32 v173, v173, v205
    v_add_f32 v174, v174, v206
    v_add_f32 v175, v175, v207
    v_add_f32 v176, v176, v208
    v_add_f32 v177, v177, v209
    v_add_f32 v178, v178, v210
    v_add_f32 v179, v179, v211
    v_add_f32 v180, v180, v212
    v_add_f32 v181, v181, v213
    v_add_f32 v182, v182, v214
    v_add_f32 v183, v183, v215
    s_waitcnt vmcnt(0)
    v_permlane16_swap_b32 v152, v160
    v_permlane16_swap_b32 v153, v161
    v_permlane16_swap_b32 v154, v162
    v_permlane16_swap_b32 v155, v163
    v_lshlrev_b32 v24, 16, v232
    v_and_b32 v25, 0xffff0000, v232
    v_lshlrev_b32 v26, 16, v233
    v_and_b32 v27, 0xffff0000, v233
    v_lshlrev_b32 v28, 16, v234
    v_and_b32 v29, 0xffff0000, v234
    v_lshlrev_b32 v30, 16, v235
    v_and_b32 v31, 0xffff0000, v235
    v_add_f32 v152, v152, v24
    v_add_f32 v160, v160, v28
    v_add_f32 v153, v153, v25
    v_add_f32 v161, v161, v29
    v_add_f32 v154, v154, v26
    v_add_f32 v162, v162, v30
    v_add_f32 v155, v155, v27
    v_add_f32 v163, v163, v31
    v_cvt_pk_bf16_f32 v32, v152, v153
    v_cvt_pk_bf16_f32 v33, v154, v155
    v_cvt_pk_bf16_f32 v34, v160, v161
    v_cvt_pk_bf16_f32 v35, v162, v163
    buffer_store_dwordx4 v[32:35], v11, s[28:31], s54 offen offset:0 nt
    v_permlane16_swap_b32 v168, v176
    v_permlane16_swap_b32 v169, v177
    v_permlane16_swap_b32 v170, v178
    v_permlane16_swap_b32 v171, v179
    v_lshlrev_b32 v24, 16, v236
    v_and_b32 v25, 0xffff0000, v236
    v_lshlrev_b32 v26, 16, v237
    v_and_b32 v27, 0xffff0000, v237
    v_lshlrev_b32 v28, 16, v238
    v_and_b32 v29, 0xffff0000, v238
    v_lshlrev_b32 v30, 16, v239
    v_and_b32 v31, 0xffff0000, v239
    v_add_f32 v168, v168, v24
    v_add_f32 v176, v176, v28
    v_add_f32 v169, v169, v25
    v_add_f32 v177, v177, v29
    v_add_f32 v170, v170, v26
    v_add_f32 v178, v178, v30
    v_add_f32 v171, v171, v27
    v_add_f32 v179, v179, v31
    v_cvt_pk_bf16_f32 v36, v168, v169
    v_cvt_pk_bf16_f32 v37, v170, v171
    v_cvt_pk_bf16_f32 v38, v176, v177
    v_cvt_pk_bf16_f32 v39, v178, v179
    buffer_store_dwordx4 v[36:39], v11, s[28:31], s54 offen offset:64 nt
    v_permlane16_swap_b32 v156, v164
    v_permlane16_swap_b32 v157, v165
    v_permlane16_swap_b32 v158, v166
    v_permlane16_swap_b32 v159, v167
    v_lshlrev_b32 v24, 16, v240
    v_and_b32 v25, 0xffff0000, v240
    v_lshlrev_b32 v26, 16, v241
    v_and_b32 v27, 0xffff0000, v241
    v_lshlrev_b32 v28, 16, v242
    v_and_b32 v29, 0xffff0000, v242
    v_lshlrev_b32 v30, 16, v243
    v_and_b32 v31, 0xffff0000, v243
    v_add_f32 v156, v156, v24
    v_add_f32 v164, v164, v28
    v_add_f32 v157, v157, v25
    v_add_f32 v165, v165, v29
    v_add_f32 v158, v158, v26
    v_add_f32 v166, v166, v30
    v_add_f32 v159, v159, v27
    v_add_f32 v167, v167, v31
    v_cvt_pk_bf16_f32 v40, v156, v157
    v_cvt_pk_bf16_f32 v41, v158, v159
    v_cvt_pk_bf16_f32 v42, v164, v165
    v_cvt_pk_bf16_f32 v43, v166, v167
    buffer_store_dwordx4 v[40:43], v11, s[28:31], s57 offen offset:0 nt
    v_permlane16_swap_b32 v172, v180
    v_permlane16_swap_b32 v173, v181
    v_permlane16_swap_b32 v174, v182
    v_permlane16_swap_b32 v175, v183
    v_lshlrev_b32 v24, 16, v244
    v_and_b32 v25, 0xffff0000, v244
    v_lshlrev_b32 v26, 16, v245
    v_and_b32 v27, 0xffff0000, v245
    v_lshlrev_b32 v28, 16, v246
    v_and_b32 v29, 0xffff0000, v246
    v_lshlrev_b32 v30, 16, v247
    v_and_b32 v31, 0xffff0000, v247
    v_add_f32 v172, v172, v24
    v_add_f32 v180, v180, v28
    v_add_f32 v173, v173, v25
    v_add_f32 v181, v181, v29
    v_add_f32 v174, v174, v26
    v_add_f32 v182, v182, v30
    v_add_f32 v175, v175, v27
    v_add_f32 v183, v183, v31
    v_cvt_pk_bf16_f32 v44, v172, v173
    v_cvt_pk_bf16_f32 v45, v174, v175
    v_cvt_pk_bf16_f32 v46, v180, v181
    v_cvt_pk_bf16_f32 v47, v182, v183
    buffer_store_dwordx4 v[44:47], v11, s[28:31], s57 offen offset:64 nt
G1_done:
    s_endpgm
.fill 2048, 4, 0xbf800000
.section .rodata,"a"
.p2align 6
.amdhsa_kernel parallel_sum__linear_kernel_hedgehog__glu_gated_glu__prompt_kernel
  .amdhsa_next_free_vgpr 256
  .amdhsa_next_free_sgpr 102
  .amdhsa_accum_offset 256
  .amdhsa_group_segment_fixed_size 0
  .amdhsa_kernarg_size 88
  .amdhsa_user_sgpr_count 2
  .amdhsa_user_sgpr_kernarg_segment_ptr 1
  .amdhsa_system_sgpr_workgroup_id_x 1
.end_amdhsa_kernel
.text
```
